```python
import torch

def _softmax(x, axis=-1):
    return torch.softmax(x, dim=axis)
def _gelu(x):
    return torch.nn.functional.gelu(x, approximate="tanh")
def _silu(x):
    return torch.nn.functional.silu(x)
def _sigmoid(x):
    return torch.sigmoid(x)
def _layernorm(x, axis=-1, eps=1e-5):
    m = x.mean(dim=axis, keepdim=True)
    v = x.var(dim=axis, keepdim=True, unbiased=False)
    return (x - m) / torch.sqrt(v + eps)
def _scatter_add(tgt, idx, src, axis=0):
    return tgt.clone().index_add_(axis, idx, src)
def _segment_sum(src, seg, n):
    out = torch.zeros((n,) + src.shape[1:], dtype=src.dtype)
    return out.index_add_(0, seg, src)
def _pad(x, pw):
    flat = tuple(v for pair in reversed(pw) for v in pair)
    return torch.nn.functional.pad(x, flat)

kernel_name = 'parallel_sum__linear_attn_block__dense_activation_mish__prompt'

def setup_inputs():

    _w = (lambda a: (lambda t: t.to(torch.bfloat16) if t.is_floating_point() else t)(torch.as_tensor(a)))
    def _A_setup():
        B, S, D = 1, 2048, 512
        return {
            "x": _w((lambda *s: torch.randn(*s, dtype=torch.bfloat16) * 0.05)(B, S, D)),
            "wqkv": _w((lambda *s: torch.randn(*s, dtype=torch.bfloat16) * 0.1)(D, 3 * D)),
            "wo": _w((lambda *s: torch.randn(*s, dtype=torch.bfloat16) * 0.05)(D, D)),
        }
    _A_in = _A_setup()

    def _B_setup():
        B, S, D, F = 1, 2048, 512, 1376
        return {
            "x": _w((lambda *s: torch.randn(*s, dtype=torch.bfloat16) * 0.05)(B, S, D)),
            "w1": _w((lambda *s: torch.randn(*s, dtype=torch.bfloat16) * 0.8)(D, F) * (D ** -0.5)),
            "b1": _w((lambda *s: torch.randn(*s, dtype=torch.bfloat16) * 0.4)(F)),
            "w2": _w((lambda *s: torch.randn(*s, dtype=torch.bfloat16) * 0.1)(F, D) * (F ** -0.5)),
        }
    _B_in = _B_setup()

    return {
        "A_x": _A_in["x"],
        "A_wqkv": _A_in["wqkv"],
        "A_wo": _A_in["wo"],
        "B_x": _B_in["x"],
        "B_w1": _B_in["w1"],
        "B_b1": _B_in["b1"],
        "B_w2": _B_in["w2"],
    }

def reference(A_x, A_wqkv, A_wo, B_x, B_w1, B_b1, B_w2):
    def _A_ref(x, wqkv, wo):
        B, S, D = x.shape
        H = 32; Dh = D // H
        qkv = (lambda x, *d: x.permute(*d))((x @ wqkv).reshape(B, S, 3, H, Dh), 2, 0, 3, 1, 4)
        q, k, v = qkv[0], qkv[1], qkv[2]
        phi = lambda t: torch.where(t > 0, t + 1, torch.exp(t)) + 1e-6
        pq, pk = phi(q), phi(k)
        kv = torch.einsum("bhsd,bhse->bhde", pk, v)
        z = torch.einsum("bhsd->bhd", pk)
        num = torch.einsum("bhqd,bhde->bhqe", pq, kv)
        den = torch.einsum("bhqd,bhd->bhq", pq, z)[..., None] + 1e-6
        o = num / den
        return (lambda x, *d: x.permute(*d))(o, 0, 2, 1, 3).reshape(B, S, D) @ wo

    def _B_ref(x, w1, b1, w2):
        h = torch.einsum("bsd,df->bsf", x, w1) + b1
        sp = torch.log1p(torch.exp(-torch.abs(h))) + torch.where(h > 0, h, torch.zeros_like(h))
        act = h * torch.tanh(sp)
        return torch.einsum("bsf,fd->bsd", act, w2)

    x = A_x
    xn = _layernorm(x, axis=-1)
    return x + _A_ref(xn, A_wqkv, A_wo) + _B_ref(xn, B_w1, B_b1, B_w2)
```

```asm
; @launch grid=(256,1,1) block=(512,1,1) lds=163840
.amdgcn_target "amdgcn-amd-amdhsa--gfx950"
.text
.globl parallel_sum__linear_attn_block__dense_activation_mish__prompt_kernel
.p2align 8
.type parallel_sum__linear_attn_block__dense_activation_mish__prompt_kernel,@function
parallel_sum__linear_attn_block__dense_activation_mish__prompt_kernel:
L_code0:
    s_cmp_ge_u32 s2, 256
    s_cbranch_scc1 L_end
    s_load_dwordx16 s[4:19], s[0:1], 0
    s_load_dwordx4 s[20:23], s[0:1], 64
    s_getpc_b64 s[78:79]
    s_bfe_u32 s77, s2, 0x30003
    s_mul_i32 s77, s77, 5120
    v_lshlrev_b32 v2, 4, v0
    v_min_u32 v2, 4992, v2
    v_add_u32 v2, s77, v2
L_pc:
    v_min_u32 v2, L_codeend-L_pc, v2
    s_mov_b32 exec_lo, 0x01010101
    s_mov_b32 exec_hi, 0x01010101
    global_load_dword v251, v2, s[78:79]
    s_mov_b64 exec, -1
    v_lshrrev_b32 v1, 6, v0
    v_and_b32 v0, 63, v0
    v_readfirstlane_b32 s52, v1
    s_bfe_u32 s77, s2, 0x30003
    s_and_b32 s78, s2, 1
    s_lshl3_add_u32 s55, s78, s77
    s_lshr_b32 s78, s2, 6
    s_bfe_u32 s79, s2, 0x20001
    s_xor_b32 s79, s79, 3
    s_lshl2_add_u32 s56, s78, s79
    s_sub_u32 s77, s56, 8
    s_min_u32 s78, s77, 3
    s_mul_i32 s76, s77, 5
    s_add_u32 s76, s76, s78
    v_lshlrev_b32 v1, 4, v0
    s_cmp_lt_u32 s52, 4
    s_cbranch_scc1 L_C
    s_bfe_u32 s77, s2, 0x30003
    s_lshr_b32 s78, s2, 6
    s_lshl1_add_u32 s57, s78, s77
    s_and_b32 s57, s57, 7
    s_sub_u32 s53, s52, 4
    s_movk_i32 s83, 2752
    s_cmp_lt_u32 s56, 8
    s_cselect_b32 s83, 3072, s83
    s_cselect_b32 s69, 0, 896
    s_cselect_b32 s80, 0, 2048
    s_lshl_b32 s77, s56, 7
    s_lshl_b32 s78, s76, 6
    s_cmp_lt_u32 s56, 8
    s_cselect_b32 s82, s77, s78
    s_add_u32 s82, s82, s80
    v_lshrrev_b32 v20, 4, v0
    v_and_b32 v21, 7, v0
    v_xor_b32 v20, v20, v21
    v_lshlrev_b32 v20, 4, v20
    v_lshrrev_b32 v22, 3, v0
    v_lshl_add_u32 v2, v22, 10, v20
    v_xor_b32 v3, 64, v2
    v_add_u32 v3, 7168, v3
    v_add_u32 v4, 14336, v2
    v_add_u32 v5, 14336, v3
    v_lshrrev_b32 v20, 2, v0
    v_and_b32 v20, 4, v20
    v_xor_b32 v20, v20, v21
    v_lshlrev_b32 v20, 4, v20
    s_cmp_ge_u32 s56, 11
    s_cselect_b32 s81, 64, 128
    v_mad_u32_u24 v6, v22, s83, v20
    v_cmp_gt_u32 vcc, s81, v20
    v_mov_b32 v7, 1073741824
    s_lshl_b32 s77, s83, 3
    v_cndmask_b32 v7, v7, v6, vcc
    v_xor_b32 v8, 32, v6
    v_xor_b32 v9, 32, v7
    v_add_u32 v8, s77, v8
    v_add_u32 v9, s77, v9
    s_lshl2_add_u32 s66, s55, s53
    s_lshl_b32 s66, s66, 15
    s_lshl_b32 s64, s83, 6
    s_lshl_b32 s65, s83, 9
    s_lshl2_add_u32 s77, s57, s53
    s_lshl_b32 s77, s77, 4
    s_mul_i32 s63, s77, s83
    s_add_u32 s63, s63, s82
    s_lshl_b32 s67, s53, 12
    s_mul_i32 s68, s53, 6144
    s_add_u32 s68, s68, 49152
    s_mov_b32 s26, 2097152
    s_mov_b32 s27, 0x20000
    s_add_u32 s30, s65, s80
    s_mov_b32 s31, 0x20000
    s_waitcnt lgkmcnt(0)
    s_load_dword s61, s[22:23], 0
    s_mov_b32 s24, s4
    s_mov_b32 s25, s5
    s_sub_u32 s12, s12, 2048
    s_subb_u32 s13, s13, 0
    s_cmp_lt_u32 s56, 8
    s_cselect_b32 s28, s6, s12
    s_cselect_b32 s29, s7, s13
    s_add_u32 m0, s68, 0
    s_sub_u32 s70, s63, s69
    s_sub_u32 s71, s70, s69
    buffer_load_dwordx4 v6, s[28:31], s63 offen lds
    buffer_load_dwordx4 v6, s[28:31], s70 offen offset:1024 lds
    buffer_load_dwordx4 v7, s[28:31], s71 offen offset:2048 lds
    s_add_u32 m0, s68, 3072
    s_nop 0
    buffer_load_dwordx4 v8, s[28:31], s63 offen lds
    buffer_load_dwordx4 v8, s[28:31], s70 offen offset:1024 lds
    buffer_load_dwordx4 v9, s[28:31], s71 offen offset:2048 lds
    s_add_u32 m0, s67, 0
    s_lshl_b32 s62, s57, 7
    s_add_u32 s62, s62, s66
    buffer_load_dwordx4 v2, s[24:27], s62 offen lds
    buffer_load_dwordx4 v3, s[24:27], s62 offen offset:1024 lds
    buffer_load_dwordx4 v4, s[24:27], s62 offen offset:2048 lds
    buffer_load_dwordx4 v5, s[24:27], s62 offen offset:3072 lds
    s_add_u32 s63, s63, s64
    s_add_u32 s57, s57, 1
    s_and_b32 s57, s57, 7
    s_cselect_b32 s77, 0, s65
    s_sub_u32 s63, s63, s77
    v_lshrrev_b32 v20, 4, v0
    v_lshlrev_b32 v20, 1, v20
    v_xor_b32 v20, v20, v21
    v_lshlrev_b32 v20, 4, v20
    v_lshl_add_u32 v10, v22, 10, v20
    v_add_u32 v11, 7168, v10
    s_mov_b32 s40, s22
    s_mov_b32 s41, s23
    s_mov_b32 s42, 16777216
    s_mov_b32 s43, 0x20000
    s_mov_b32 s32, s16
    s_mov_b32 s33, s17
    s_mov_b32 s34, 1409024
    s_mov_b32 s35, 0x20000
    s_mov_b32 s36, s8
    s_mov_b32 s37, s9
    s_mov_b32 s38, 524288
    s_mov_b32 s39, 0x20000
    s_mov_b32 s44, s18
    s_mov_b32 s45, s19
    s_mov_b32 s46, 2097152
    s_mov_b32 s47, 0x20000
    s_and_b32 s77, s2, 7
    s_lshr_b32 s78, s2, 3
    s_and_b32 s58, s78, 7
    s_lshr_b32 s78, s78, 3
    s_xor_b32 s78, s78, 2
    s_and_b32 s60, s58, 1
    s_lshl1_add_u32 s60, s78, s60
    s_lshr_b32 s78, s58, 1
    s_mov_b32 s58, s60
    s_lshr_b32 s59, s77, 1
    s_and_b32 s77, s77, 1
    s_lshl2_add_u32 s77, s77, s59
    s_lshl2_add_u32 s59, s77, s78
    s_lshl1_add_u32 s60, s78, s58
    v_bfe_u32 v20, v0, 2, 2
    v_lshrrev_b32 v21, 1, v20
    v_lshlrev_b32 v20, 7, v20
    v_lshl_add_u32 v20, v21, 6, v20
    v_bfe_u32 v21, v0, 4, 1
    v_lshl_add_u32 v20, v21, 5, v20
    v_and_b32 v21, 3, v0
    v_lshl_add_u32 v34, v21, 3, v20
    v_lshrrev_b32 v35, 5, v0
    s_lshl_b32 s72, s53, 11
    v_lshrrev_b32 v20, 2, v0
    v_lshlrev_b32 v20, 7, v20
    v_lshl_add_u32 v20, v21, 3, v20
    v_bfe_u32 v21, v0, 3, 2
    v_lshl_add_u32 v20, v21, 5, v20
    v_add_u32 v132, s72, v20
    v_xor_b32 v133, 32, v132
    v_xor_b32 v134, 64, v132
    v_xor_b32 v135, 96, v132
    v_add_u32 v136, 65536, v132
    v_add_u32 v137, 65536, v133
    v_add_u32 v138, 65536, v134
    v_add_u32 v139, 65536, v135
    v_add_u32 v140, 65536, v136
    v_add_u32 v141, 65536, v137
    v_add_u32 v142, 65536, v138
    v_add_u32 v143, 65536, v139
    v_and_b32 v20, 31, v0
    v_lshlrev_b32 v20, 2, v20
    v_add_u32 v20, 162304, v20
    v_mov_b32 v21, 0
    ds_write_b32 v20, v21
    s_waitcnt lgkmcnt(0)
    s_mul_i32 s77, s60, 3
    s_lshr_b32 s77, s77, 1
    s_sub_u32 s78, s77, 11
    s_cmp_ge_u32 s77, 11
    s_cselect_b32 s77, s78, s77
    s_mul_i32 s80, s53, 11
    s_add_u32 s81, s80, 11
    s_add_u32 s77, s77, s80
    s_lshl_b32 s4, s77, 10
    s_cmp_ge_u32 s77, 43
    s_cselect_b32 s4, 16777216, s4
    s_add_u32 s77, s77, 1
    s_cmp_eq_u32 s77, s81
    s_cselect_b32 s77, s80, s77
    s_lshl_b32 s5, s77, 10
    s_cmp_ge_u32 s77, 43
    s_cselect_b32 s5, 16777216, s5
    s_add_u32 s77, s77, 1
    s_cmp_eq_u32 s77, s81
    s_cselect_b32 s77, s80, s77
    s_lshl_b32 s6, s77, 10
    s_cmp_ge_u32 s77, 43
    s_cselect_b32 s6, 16777216, s6
    s_add_u32 s77, s77, 1
    s_cmp_eq_u32 s77, s81
    s_cselect_b32 s77, s80, s77
    s_lshl_b32 s7, s77, 10
    s_cmp_ge_u32 s77, 43
    s_cselect_b32 s7, 16777216, s7
    s_add_u32 s77, s77, 1
    s_cmp_eq_u32 s77, s81
    s_cselect_b32 s77, s80, s77
    s_lshl_b32 s8, s77, 10
    s_cmp_ge_u32 s77, 43
    s_cselect_b32 s8, 16777216, s8
    s_add_u32 s77, s77, 1
    s_cmp_eq_u32 s77, s81
    s_cselect_b32 s77, s80, s77
    s_lshl_b32 s9, s77, 10
    s_cmp_ge_u32 s77, 43
    s_cselect_b32 s9, 16777216, s9
    s_add_u32 s77, s77, 1
    s_cmp_eq_u32 s77, s81
    s_cselect_b32 s77, s80, s77
    s_lshl_b32 s10, s77, 10
    s_cmp_ge_u32 s77, 43
    s_cselect_b32 s10, 16777216, s10
    s_add_u32 s77, s77, 1
    s_cmp_eq_u32 s77, s81
    s_cselect_b32 s77, s80, s77
    s_lshl_b32 s11, s77, 10
    s_cmp_ge_u32 s77, 43
    s_cselect_b32 s11, 16777216, s11
    s_add_u32 s77, s77, 1
    s_cmp_eq_u32 s77, s81
    s_cselect_b32 s77, s80, s77
    s_lshl_b32 s12, s77, 10
    s_cmp_ge_u32 s77, 43
    s_cselect_b32 s12, 16777216, s12
    s_add_u32 s77, s77, 1
    s_cmp_eq_u32 s77, s81
    s_cselect_b32 s77, s80, s77
    s_lshl_b32 s13, s77, 10
    s_cmp_ge_u32 s77, 43
    s_cselect_b32 s13, 16777216, s13
    s_add_u32 s77, s77, 1
    s_cmp_eq_u32 s77, s81
    s_cselect_b32 s77, s80, s77
    s_lshl_b32 s14, s77, 10
    s_cmp_ge_u32 s77, 43
    s_cselect_b32 s14, 16777216, s14
    s_lshl_b32 s80, s53, 2
    s_add_u32 s80, s80, 44
    s_add_u32 s77, s60, 0
    s_and_b32 s77, s77, 3
    s_add_u32 s77, s77, s80
    s_lshl_b32 s15, s77, 10
    s_add_u32 s77, s60, 1
    s_and_b32 s77, s77, 3
    s_add_u32 s77, s77, s80
    s_lshl_b32 s16, s77, 10
    s_add_u32 s77, s60, 2
    s_and_b32 s77, s77, 3
    s_add_u32 s77, s77, s80
    s_lshl_b32 s17, s77, 10
    s_add_u32 s77, s60, 3
    s_and_b32 s77, s77, 3
    s_add_u32 s77, s77, s80
    s_lshl_b32 s18, s77, 10
    s_lshl_b32 s19, s58, 7
    s_add_u32 s20, s19, 16384
    s_sub_u32 s21, s19, 1441792
    s_add_u32 s22, s21, 16384
    s_mul_i32 s75, s59, 245760
    s_add_u32 s75, s75, 2097152
    v_add_u32 v248, 61440, v1
    v_add_u32 v12, 122880, v1
    v_add_u32 v13, 184320, v1
    s_mul_i32 s61, s61, 0x9e3779b1
    s_add_u32 s61, s61, 0x7f4a7c15
    s_lshl2_add_u32 s86, s55, s53
    s_lshl_b32 s86, s86, 9
    s_add_u32 s86, s86, 4096
    s_and_b32 s87, s55, 8
    s_lshl4_add_u32 s87, s56, s87
    s_lshl2_add_u32 s87, s87, s53
    s_lshl_b32 s87, s87, 8
    s_add_u32 s87, s87, 65536
    v_and_b32 v60, 0x1f0, v1
    v_lshrrev_b32 v61, 4, v0
    v_lshlrev_b32 v61, 10, v61
    v_and_b32 v62, 0xf0, v1
    v_or_b32 v61, v61, v62
    v_add_u32 v62, 4096, v61
    v_and_b32 v20, 7, v0
    v_lshrrev_b32 v21, 4, v0
    v_xor_b32 v21, v21, v20
    v_lshlrev_b32 v21, 4, v21
    v_lshl_add_u32 v21, v20, 8, v21
    v_bfe_u32 v20, v0, 3, 1
    v_lshl_add_u32 v21, v20, 13, v21
    v_add_u32 v254, s72, v21
    s_lshl_b32 s54, s59, 12
    s_add_u32 s54, s54, 1048576
    v_and_b32 v249, 3, v0
    s_lshl_b32 s77, s53, 2
    v_add_u32 v249, s77, v249
    v_lshlrev_b32 v249, 7, v249
    s_lshl_b32 s77, s53, 3
    s_or_b32 s77, s77, 0x80000
    s_bfe_u32 s78, 0x0c060200, s77
    s_bfe_u32 s77, 0x03050503, s77
    v_min_u32 v250, s77, v0
    v_add_u32 v250, s78, v250
    v_lshlrev_b32 v250, 7, v250
    v_lshrrev_b32 v20, 3, v0
    v_and_b32 v21, 7, v0
    v_lshlrev_b32 v18, 10, v20
    v_lshl_add_u32 v18, v21, 4, v18
    s_lshl3_add_u32 s77, s59, s52
    s_lshl_b32 s77, s77, 13
    s_lshl_b32 s78, s58, 7
    s_add_u32 s3, s77, s78
    v_lshlrev_b32 v21, 1, v21
    v_xor_b32 v21, v21, v20
    v_lshlrev_b32 v21, 4, v21
    v_lshl_add_u32 v17, v20, 8, v21
    s_lshl_b32 s77, s52, 13
    v_add_u32 v17, s77, v17
    v_and_b32 v255, 3, v0
    v_lshlrev_b32 v255, 2, v255
    v_add_u32 v255, 162304, v255
    s_mul_i32 s77, s53, 3072
    s_add_u32 s77, s77, 147468
    v_add_u32 v20, s77, v1
    s_not_b32 s77, s61
    v_mov_b32 v21, s77
    ds_write_b32 v20, v21 offset:0
    ds_write_b32 v20, v21 offset:1024
    ds_write_b32 v20, v21 offset:2048
    s_mul_i32 s77, s53, 6144
    s_add_u32 s77, s77, 49152
    v_mul_u32_u24 v20, 3072, v35
    v_add3_u32 v20, v20, v34, s77
    v_lshlrev_b32 v21, 5, v35
    v_xor_b32 v20, v20, v21
    v_xor_b32 v21, 64, v20
    s_mov_b32 s82, 0x3f803f80
    v_mov_b32 v36, 0
    v_mov_b32 v37, 0
    v_mov_b32 v38, 0
    v_mov_b32 v39, 0
    v_mov_b32 v40, 0
    v_mov_b32 v41, 0
    s_mul_i32 s78, s53, 1536
    s_add_u32 s78, s78, 122880
    v_and_b32 v22, 31, v0
    v_lshl_add_u32 v22, v22, 2, s78
    v_mul_u32_u24 v23, 768, v35
    v_add_u32 v22, v22, v23
    s_waitcnt vmcnt(8)
    s_add_u32 m0, s67, 16384
    s_lshl_b32 s62, s57, 7
    s_add_u32 s62, s62, s66
    buffer_load_dwordx4 v2, s[24:27], s62 offen lds
    buffer_load_dwordx4 v3, s[24:27], s62 offen offset:1024 lds
    buffer_load_dwordx4 v4, s[24:27], s62 offen offset:2048 lds
    buffer_load_dwordx4 v5, s[24:27], s62 offen offset:3072 lds
    s_add_u32 m0, s68, 24576
    s_sub_u32 s70, s63, s69
    s_sub_u32 s71, s70, s69
    buffer_load_dwordx4 v6, s[28:31], s63 offen lds
    buffer_load_dwordx4 v6, s[28:31], s70 offen offset:1024 lds
    buffer_load_dwordx4 v7, s[28:31], s71 offen offset:2048 lds
    s_add_u32 m0, s68, 27648
    s_nop 0
    buffer_load_dwordx4 v8, s[28:31], s63 offen lds
    buffer_load_dwordx4 v8, s[28:31], s70 offen offset:1024 lds
    buffer_load_dwordx4 v9, s[28:31], s71 offen offset:2048 lds
    s_add_u32 s63, s63, s64
    s_add_u32 s57, s57, 1
    s_and_b32 s57, s57, 7
    s_cselect_b32 s77, 0, s65
    s_sub_u32 s63, s63, s77
    s_waitcnt vmcnt(14)
    ds_read_b64_tr_b16 v[84:85], v20 offset:0
    ds_read_b64_tr_b16 v[86:87], v20 offset:512
    ds_read_b64_tr_b16 v[88:89], v21 offset:0
    ds_read_b64_tr_b16 v[90:91], v21 offset:512
    ds_read_b64_tr_b16 v[92:93], v20 offset:1024
    ds_read_b64_tr_b16 v[94:95], v20 offset:1536
    ds_read_b64_tr_b16 v[96:97], v21 offset:1024
    ds_read_b64_tr_b16 v[98:99], v21 offset:1536
    ds_read_b64_tr_b16 v[100:101], v20 offset:2048
    ds_read_b64_tr_b16 v[102:103], v20 offset:2560
    ds_read_b64_tr_b16 v[104:105], v21 offset:2048
    ds_read_b64_tr_b16 v[106:107], v21 offset:2560
    s_waitcnt lgkmcnt(6)
    v_dot2c_f32_bf16 v36, s82, v84
    v_dot2c_f32_bf16 v37, s82, v88
    v_dot2c_f32_bf16 v38, s82, v92
    v_dot2c_f32_bf16 v36, s82, v85
    v_dot2c_f32_bf16 v37, s82, v89
    v_dot2c_f32_bf16 v38, s82, v93
    v_dot2c_f32_bf16 v36, s82, v86
    v_dot2c_f32_bf16 v37, s82, v90
    v_dot2c_f32_bf16 v38, s82, v94
    v_dot2c_f32_bf16 v36, s82, v87
    v_dot2c_f32_bf16 v37, s82, v91
    v_dot2c_f32_bf16 v38, s82, v95
    s_waitcnt lgkmcnt(0)
    v_dot2c_f32_bf16 v39, s82, v96
    v_dot2c_f32_bf16 v40, s82, v100
    v_dot2c_f32_bf16 v41, s82, v104
    v_dot2c_f32_bf16 v39, s82, v97
    v_dot2c_f32_bf16 v40, s82, v101
    v_dot2c_f32_bf16 v41, s82, v105
    v_dot2c_f32_bf16 v39, s82, v98
    v_dot2c_f32_bf16 v40, s82, v102
    v_dot2c_f32_bf16 v41, s82, v106
    v_dot2c_f32_bf16 v39, s82, v99
    v_dot2c_f32_bf16 v40, s82, v103
    v_dot2c_f32_bf16 v41, s82, v107
    s_nop 2
    ds_write_b32 v22, v36 offset:0
    ds_write_b32 v22, v37 offset:128
    ds_write_b32 v22, v38 offset:256
    ds_write_b32 v22, v39 offset:384
    ds_write_b32 v22, v40 offset:512
    ds_write_b32 v22, v41 offset:640
    s_waitcnt vmcnt(10) lgkmcnt(0)
    s_barrier
    s_add_u32 m0, s67, 32768
    s_lshl_b32 s62, s57, 7
    s_add_u32 s62, s62, s66
    buffer_load_dwordx4 v2, s[24:27], s62 offen lds
    buffer_load_dwordx4 v3, s[24:27], s62 offen offset:1024 lds
    buffer_load_dwordx4 v4, s[24:27], s62 offen offset:2048 lds
    buffer_load_dwordx4 v5, s[24:27], s62 offen offset:3072 lds
    s_add_u32 m0, s68, 49152
    s_sub_u32 s70, s63, s69
    s_sub_u32 s71, s70, s69
    buffer_load_dwordx4 v6, s[28:31], s63 offen lds
    buffer_load_dwordx4 v6, s[28:31], s70 offen offset:1024 lds
    buffer_load_dwordx4 v7, s[28:31], s71 offen offset:2048 lds
    s_add_u32 m0, s68, 52224
    s_nop 0
    buffer_load_dwordx4 v8, s[28:31], s63 offen lds
    buffer_load_dwordx4 v8, s[28:31], s70 offen offset:1024 lds
    buffer_load_dwordx4 v9, s[28:31], s71 offen offset:2048 lds
    s_add_u32 s63, s63, s64
    s_add_u32 s57, s57, 1
    s_and_b32 s57, s57, 7
    s_cselect_b32 s77, 0, s65
    s_sub_u32 s63, s63, s77
    s_mov_b32 s77, 1073741824
    s_cmp_lg_u32 s53, 0
    s_cbranch_scc1 L_nocsp0
    v_lshlrev_b32 v44, 2, v0
    v_add_u32 v44, 122880, v44
    ds_read2st64_b32 v[148:149], v44 offset0:0 offset1:1
    ds_read2st64_b32 v[150:151], v44 offset0:2 offset1:3
    ds_read2st64_b32 v[152:153], v44 offset0:4 offset1:5
    ds_read2st64_b32 v[154:155], v44 offset0:6 offset1:7
    ds_read2st64_b32 v[156:157], v44 offset0:8 offset1:9
    ds_read2st64_b32 v[158:159], v44 offset0:10 offset1:11
    ds_read2st64_b32 v[160:161], v44 offset0:12 offset1:13
    ds_read2st64_b32 v[162:163], v44 offset0:14 offset1:15
    ds_read2st64_b32 v[164:165], v44 offset0:16 offset1:17
    ds_read2st64_b32 v[166:167], v44 offset0:18 offset1:19
    ds_read2st64_b32 v[168:169], v44 offset0:20 offset1:21
    ds_read2st64_b32 v[170:171], v44 offset0:22 offset1:23
    v_mov_b32 v47, s61
    s_lshl4_add_u32 s77, s56, s55
    s_lshl_b32 s77, s77, 10
    s_add_u32 s77, s77, 65536
    s_waitcnt lgkmcnt(0)
    v_add_f32 v148, v148, v151
    v_add_f32 v149, v149, v152
    v_add_f32 v150, v150, v153
    v_add_f32 v148, v148, v154
    v_add_f32 v149, v149, v155
    v_add_f32 v150, v150, v156
    v_add_f32 v148, v148, v157
    v_add_f32 v149, v149, v158
    v_add_f32 v150, v150, v159
    v_add_f32 v148, v148, v160
    v_add_f32 v149, v149, v161
    v_add_f32 v150, v150, v162
    v_add_f32 v148, v148, v163
    v_add_f32 v149, v149, v164
    v_add_f32 v150, v150, v165
    v_add_f32 v148, v148, v166
    v_add_f32 v149, v149, v167
    v_add_f32 v150, v150, v168
    v_add_f32 v44, v148, v169
    v_add_f32 v45, v149, v170
    v_add_f32 v46, v150, v171
L_nocsp0:
    buffer_store_dwordx4 v[44:47], v1, s[40:43], s77 offen sc1
    s_waitcnt vmcnt(11) lgkmcnt(0)
    s_barrier
    s_add_u32 m0, s67, 0
    s_lshl_b32 s62, s57, 7
    s_add_u32 s62, s62, s66
    buffer_load_dwordx4 v2, s[24:27], s62 offen lds
    buffer_load_dwordx4 v3, s[24:27], s62 offen offset:1024 lds
    buffer_load_dwordx4 v4, s[24:27], s62 offen offset:2048 lds
    buffer_load_dwordx4 v5, s[24:27], s62 offen offset:3072 lds
    s_add_u32 m0, s68, 0
    s_sub_u32 s70, s63, s69
    s_sub_u32 s71, s70, s69
    buffer_load_dwordx4 v6, s[28:31], s63 offen lds
    buffer_load_dwordx4 v6, s[28:31], s70 offen offset:1024 lds
    buffer_load_dwordx4 v7, s[28:31], s71 offen offset:2048 lds
    s_add_u32 m0, s68, 3072
    s_nop 0
    buffer_load_dwordx4 v8, s[28:31], s63 offen lds
    buffer_load_dwordx4 v8, s[28:31], s70 offen offset:1024 lds
    buffer_load_dwordx4 v9, s[28:31], s71 offen offset:2048 lds
    s_add_u32 s63, s63, s64
    s_add_u32 s57, s57, 1
    s_and_b32 s57, s57, 7
    s_cselect_b32 s77, 0, s65
    s_sub_u32 s63, s63, s77
    s_waitcnt vmcnt(11) lgkmcnt(0)
    s_barrier
    s_add_u32 m0, s67, 16384
    s_lshl_b32 s62, s57, 7
    s_add_u32 s62, s62, s66
    buffer_load_dwordx4 v2, s[24:27], s62 offen lds
    buffer_load_dwordx4 v3, s[24:27], s62 offen offset:1024 lds
    buffer_load_dwordx4 v4, s[24:27], s62 offen offset:2048 lds
    buffer_load_dwordx4 v5, s[24:27], s62 offen offset:3072 lds
    s_add_u32 m0, s68, 24576
    s_sub_u32 s70, s63, s69
    s_sub_u32 s71, s70, s69
    buffer_load_dwordx4 v6, s[28:31], s63 offen lds
    buffer_load_dwordx4 v6, s[28:31], s70 offen offset:1024 lds
    buffer_load_dwordx4 v7, s[28:31], s71 offen offset:2048 lds
    s_add_u32 m0, s68, 27648
    s_nop 0
    buffer_load_dwordx4 v8, s[28:31], s63 offen lds
    buffer_load_dwordx4 v8, s[28:31], s70 offen offset:1024 lds
    buffer_load_dwordx4 v9, s[28:31], s71 offen offset:2048 lds
    s_add_u32 s63, s63, s64
    s_add_u32 s57, s57, 1
    s_and_b32 s57, s57, 7
    s_cselect_b32 s77, 0, s65
    s_sub_u32 s63, s63, s77
    s_waitcnt vmcnt(10) lgkmcnt(0)
    s_barrier
    s_add_u32 m0, s67, 32768
    s_lshl_b32 s62, s57, 7
    s_add_u32 s62, s62, s66
    buffer_load_dwordx4 v2, s[24:27], s62 offen lds
    buffer_load_dwordx4 v3, s[24:27], s62 offen offset:1024 lds
    buffer_load_dwordx4 v4, s[24:27], s62 offen offset:2048 lds
    buffer_load_dwordx4 v5, s[24:27], s62 offen offset:3072 lds
    s_add_u32 m0, s68, 49152
    s_sub_u32 s70, s63, s69
    s_sub_u32 s71, s70, s69
    buffer_load_dwordx4 v6, s[28:31], s63 offen lds
    buffer_load_dwordx4 v6, s[28:31], s70 offen offset:1024 lds
    buffer_load_dwordx4 v7, s[28:31], s71 offen offset:2048 lds
    s_add_u32 m0, s68, 52224
    s_nop 0
    buffer_load_dwordx4 v8, s[28:31], s63 offen lds
    buffer_load_dwordx4 v8, s[28:31], s70 offen offset:1024 lds
    buffer_load_dwordx4 v9, s[28:31], s71 offen offset:2048 lds
    s_add_u32 s63, s63, s64
    s_add_u32 s57, s57, 1
    s_and_b32 s57, s57, 7
    s_cselect_b32 s77, 0, s65
    s_sub_u32 s63, s63, s77
    s_waitcnt vmcnt(10) lgkmcnt(0)
    s_barrier
    s_add_u32 m0, s67, 0
    s_lshl_b32 s62, s57, 7
    s_add_u32 s62, s62, s66
    buffer_load_dwordx4 v2, s[24:27], s62 offen lds
    buffer_load_dwordx4 v3, s[24:27], s62 offen offset:1024 lds
    buffer_load_dwordx4 v4, s[24:27], s62 offen offset:2048 lds
    buffer_load_dwordx4 v5, s[24:27], s62 offen offset:3072 lds
    s_add_u32 m0, s68, 0
    s_sub_u32 s70, s63, s69
    s_sub_u32 s71, s70, s69
    buffer_load_dwordx4 v6, s[28:31], s63 offen lds
    buffer_load_dwordx4 v6, s[28:31], s70 offen offset:1024 lds
    buffer_load_dwordx4 v7, s[28:31], s71 offen offset:2048 lds
    s_add_u32 m0, s68, 3072
    s_nop 0
    buffer_load_dwordx4 v8, s[28:31], s63 offen lds
    buffer_load_dwordx4 v8, s[28:31], s70 offen offset:1024 lds
    buffer_load_dwordx4 v9, s[28:31], s71 offen offset:2048 lds
    s_add_u32 s63, s63, s64
    s_add_u32 s57, s57, 1
    s_and_b32 s57, s57, 7
    s_cselect_b32 s77, 0, s65
    s_sub_u32 s63, s63, s77
    s_waitcnt vmcnt(10) lgkmcnt(0)
    s_barrier
    s_add_u32 m0, s67, 16384
    s_lshl_b32 s62, s57, 7
    s_add_u32 s62, s62, s66
    buffer_load_dwordx4 v2, s[24:27], s62 offen lds
    buffer_load_dwordx4 v3, s[24:27], s62 offen offset:1024 lds
    buffer_load_dwordx4 v4, s[24:27], s62 offen offset:2048 lds
    buffer_load_dwordx4 v5, s[24:27], s62 offen offset:3072 lds
    s_add_u32 m0, s68, 24576
    s_sub_u32 s70, s63, s69
    s_sub_u32 s71, s70, s69
    buffer_load_dwordx4 v6, s[28:31], s63 offen lds
    buffer_load_dwordx4 v6, s[28:31], s70 offen offset:1024 lds
    buffer_load_dwordx4 v7, s[28:31], s71 offen offset:2048 lds
    s_add_u32 m0, s68, 27648
    s_nop 0
    buffer_load_dwordx4 v8, s[28:31], s63 offen lds
    buffer_load_dwordx4 v8, s[28:31], s70 offen offset:1024 lds
    buffer_load_dwordx4 v9, s[28:31], s71 offen offset:2048 lds
    buffer_load_dwordx4 v[84:87], v60, s[40:43], s86 offen sc1
    buffer_load_dwordx4 v[88:91], v61, s[40:43], s87 offen sc1
    buffer_load_dwordx4 v[92:95], v62, s[40:43], s87 offen sc1
    s_lshl2_add_u32 s77, s2, s53
    s_lshl_b32 s78, s77, 9
    s_mul_i32 s77, s77, 1408
    v_lshlrev_b32 v28, 7, v0
    s_mov_b64 exec, 0x7ff
    buffer_load_dword v29, v28, s[32:35], s77 offen
    s_mov_b64 exec, 0xf
    buffer_load_dword v30, v28, s[36:39], s78 offen
    s_mov_b64 exec, -1
    s_waitcnt vmcnt(15) lgkmcnt(0)
    s_barrier
    s_lshl_b32 s77, s4, 5
    s_add_u32 m0, s72, 122880
    s_add_u32 s77, s77, s19
    buffer_load_dwordx4 v10, s[32:35], s77 offen lds
    buffer_load_dwordx4 v11, s[32:35], s77 offen offset:1024 lds
    s_lshl_b32 s77, s4, 5
    s_add_u32 m0, s72, 131072
    s_add_u32 s77, s77, s20
    buffer_load_dwordx4 v10, s[32:35], s77 offen lds
    buffer_load_dwordx4 v11, s[32:35], s77 offen offset:1024 lds
    s_lshl_b32 s77, s5, 5
    s_add_u32 m0, s72, 139264
    s_add_u32 s77, s77, s19
    buffer_load_dwordx4 v10, s[32:35], s77 offen lds
    buffer_load_dwordx4 v11, s[32:35], s77 offen offset:1024 lds
    s_waitcnt vmcnt(8)
    s_mov_b32 s85, 0
L_gchk0:
    v_cmp_ne_u32 vcc, s61, v87
    v_cmp_ne_u32 s[70:71], s61, v91
    s_nop 1
    s_or_b64 s[70:71], vcc, s[70:71]
    v_cmp_ne_u32 vcc, s61, v95
    s_nop 1
    s_or_b64 vcc, vcc, s[70:71]
    s_cbranch_vccz L_gok0
    s_add_u32 s85, s85, 1
    s_cmp_gt_u32 s85, 0x8000
    s_cbranch_scc1 L_gok0
    buffer_load_dwordx4 v[84:87], v60, s[40:43], s86 offen sc1
    buffer_load_dwordx4 v[88:91], v61, s[40:43], s87 offen sc1
    buffer_load_dwordx4 v[92:95], v62, s[40:43], s87 offen sc1
    s_waitcnt vmcnt(0)
    s_branch L_gchk0
L_gok0:
    s_lshl_b32 s77, s53, 7
    s_add_u32 s77, s77, 161280
    v_and_b32 v20, 31, v0
    v_lshl_add_u32 v20, v20, 2, s77
    ds_write_b32 v20, v84
    ds_write_b32 v20, v85 offset:512
    v_add_f32 v88, v88, v92
    v_add_f32 v89, v89, v93
    v_add_f32 v90, v90, v94
    v_mov_b32 v92, v88
    v_mov_b32 v93, v89
    v_mov_b32 v94, v90
    s_nop 0
    v_permlane16_swap_b32 v92, v88
    v_permlane16_swap_b32 v93, v89
    v_permlane16_swap_b32 v94, v90
    s_nop 0
    v_add_f32 v88, v88, v92
    v_add_f32 v89, v89, v93
    v_add_f32 v90, v90, v94
    v_mov_b32 v92, v88
    v_mov_b32 v93, v89
    v_mov_b32 v94, v90
    s_nop 0
    v_permlane32_swap_b32 v92, v88
    v_permlane32_swap_b32 v93, v89
    v_permlane32_swap_b32 v94, v90
    s_nop 0
    v_add_f32 v88, v88, v92
    v_add_f32 v89, v89, v93
    v_add_f32 v90, v90, v94
    s_lshl_b32 s77, s53, 6
    s_add_u32 s77, s77, 159744
    v_lshl_add_u32 v21, v0, 2, s77
    s_mov_b64 exec, 0xffff
    ds_write2st64_b32 v21, v88, v89 offset1:1
    ds_write_b32 v21, v90 offset:512
    s_mov_b64 exec, -1
    s_waitcnt lgkmcnt(0)
    s_barrier
L_varend:
    s_lshl_b32 s77, s5, 5
    s_add_u32 m0, s72, 32768
    s_add_u32 s77, s77, s20
    buffer_load_dwordx4 v10, s[32:35], s77 offen lds
    buffer_load_dwordx4 v11, s[32:35], s77 offen offset:1024 lds
    s_lshl_b32 s77, s6, 5
    s_add_u32 m0, s72, 40960
    s_add_u32 s77, s77, s19
    buffer_load_dwordx4 v10, s[32:35], s77 offen lds
    buffer_load_dwordx4 v11, s[32:35], s77 offen offset:1024 lds
    s_lshl_b32 s77, s6, 5
    s_add_u32 m0, s72, 98304
    s_add_u32 s77, s77, s20
    buffer_load_dwordx4 v10, s[32:35], s77 offen lds
    buffer_load_dwordx4 v11, s[32:35], s77 offen offset:1024 lds
    s_lshl_b32 s77, s7, 5
    s_add_u32 m0, s72, 106496
    s_add_u32 s77, s77, s19
    buffer_load_dwordx4 v10, s[32:35], s77 offen lds
    buffer_load_dwordx4 v11, s[32:35], s77 offen offset:1024 lds
    s_waitcnt vmcnt(6)
    s_lshl_b32 s77, s7, 5
    s_add_u32 m0, s72, 114688
    s_add_u32 s77, s77, s20
    buffer_load_dwordx4 v10, s[32:35], s77 offen lds
    buffer_load_dwordx4 v11, s[32:35], s77 offen offset:1024 lds
    ds_read_b64_tr_b16 v[148:149], v136 offset:57344
    ds_read_b64_tr_b16 v[152:153], v137 offset:57344
    ds_read_b64_tr_b16 v[156:157], v138 offset:57344
    ds_read_b64_tr_b16 v[160:161], v139 offset:57344
    s_waitcnt vmcnt(6)
    s_lshl_b32 s77, s8, 5
    s_add_u32 m0, s72, 0
    s_add_u32 s77, s77, s19
    buffer_load_dwordx4 v10, s[32:35], s77 offen lds
    buffer_load_dwordx4 v11, s[32:35], s77 offen offset:1024 lds
    ds_read_b64_tr_b16 v[150:151], v140 offset:0
    ds_read_b64_tr_b16 v[154:155], v141 offset:0
    ds_read_b64_tr_b16 v[158:159], v142 offset:0
    ds_read_b64_tr_b16 v[162:163], v143 offset:0
    s_waitcnt vmcnt(6)
    s_lshl_b32 s77, s8, 5
    s_add_u32 m0, s72, 8192
    s_add_u32 s77, s77, s20
    buffer_load_dwordx4 v10, s[32:35], s77 offen lds
    buffer_load_dwordx4 v11, s[32:35], s77 offen offset:1024 lds
    ds_read_b64_tr_b16 v[164:165], v140 offset:8192
    ds_read_b64_tr_b16 v[168:169], v141 offset:8192
    ds_read_b64_tr_b16 v[172:173], v142 offset:8192
    ds_read_b64_tr_b16 v[176:177], v143 offset:8192
    s_waitcnt vmcnt(6)
    s_lshl_b32 s77, s9, 5
    s_add_u32 m0, s72, 49152
    s_add_u32 s77, s77, s19
    buffer_load_dwordx4 v10, s[32:35], s77 offen lds
    buffer_load_dwordx4 v11, s[32:35], s77 offen offset:1024 lds
    ds_read_b64_tr_b16 v[166:167], v132 offset:32768
    ds_read_b64_tr_b16 v[170:171], v133 offset:32768
    ds_read_b64_tr_b16 v[174:175], v134 offset:32768
    ds_read_b64_tr_b16 v[178:179], v135 offset:32768
    s_waitcnt vmcnt(6)
    s_lshl_b32 s77, s9, 5
    s_add_u32 m0, s72, 57344
    s_add_u32 s77, s77, s20
    buffer_load_dwordx4 v10, s[32:35], s77 offen lds
    buffer_load_dwordx4 v11, s[32:35], s77 offen offset:1024 lds
    ds_read_b64_tr_b16 v[180:181], v132 offset:40960
    ds_read_b64_tr_b16 v[184:185], v133 offset:40960
    ds_read_b64_tr_b16 v[188:189], v134 offset:40960
    ds_read_b64_tr_b16 v[192:193], v135 offset:40960
    s_waitcnt vmcnt(6)
    s_lshl_b32 s77, s10, 5
    s_add_u32 m0, s72, 65536
    s_add_u32 s77, s77, s19
    buffer_load_dwordx4 v10, s[32:35], s77 offen lds
    buffer_load_dwordx4 v11, s[32:35], s77 offen offset:1024 lds
    ds_read_b64_tr_b16 v[182:183], v136 offset:32768
    ds_read_b64_tr_b16 v[186:187], v137 offset:32768
    ds_read_b64_tr_b16 v[190:191], v138 offset:32768
    ds_read_b64_tr_b16 v[194:195], v139 offset:32768
    s_mov_b32 s85, 0
L_spring:
    ds_read_b32 v21, v255 offset:0
    s_add_u32 s85, s85, 1
    s_waitcnt lgkmcnt(0)
    v_cmp_ne_u32 vcc, 1, v21
    s_cmp_gt_u32 s85, 0x40000
    s_cbranch_scc1 L_sdring
    s_cbranch_vccnz L_spring
L_sdring:
    s_waitcnt vmcnt(6)
    s_lshl_b32 s77, s10, 5
    s_add_u32 m0, s72, 16384
    s_add_u32 s77, s77, s20
    buffer_load_dwordx4 v10, s[32:35], s77 offen lds
    buffer_load_dwordx4 v11, s[32:35], s77 offen offset:1024 lds
    ds_read_b64_tr_b16 v[196:197], v136 offset:40960
    ds_read_b64_tr_b16 v[200:201], v137 offset:40960
    ds_read_b64_tr_b16 v[204:205], v138 offset:40960
    ds_read_b64_tr_b16 v[208:209], v139 offset:40960
    s_waitcnt vmcnt(6)
    s_lshl_b32 s77, s11, 5
    s_add_u32 m0, s72, 24576
    s_add_u32 s77, s77, s19
    buffer_load_dwordx4 v10, s[32:35], s77 offen lds
    buffer_load_dwordx4 v11, s[32:35], s77 offen offset:1024 lds
    ds_read_b64_tr_b16 v[198:199], v136 offset:49152
    ds_read_b64_tr_b16 v[202:203], v137 offset:49152
    ds_read_b64_tr_b16 v[206:207], v138 offset:49152
    ds_read_b64_tr_b16 v[210:211], v139 offset:49152
    s_waitcnt vmcnt(6)
    s_lshl_b32 s77, s11, 5
    s_add_u32 m0, s72, 73728
    s_add_u32 s77, s77, s20
    buffer_load_dwordx4 v10, s[32:35], s77 offen lds
    buffer_load_dwordx4 v11, s[32:35], s77 offen offset:1024 lds
    ds_read_b64_tr_b16 v[212:213], v132 offset:0
    ds_read_b64_tr_b16 v[216:217], v133 offset:0
    ds_read_b64_tr_b16 v[220:221], v134 offset:0
    ds_read_b64_tr_b16 v[224:225], v135 offset:0
    s_waitcnt vmcnt(6)
    s_lshl_b32 s77, s12, 5
    s_add_u32 m0, s72, 81920
    s_add_u32 s77, s77, s19
    buffer_load_dwordx4 v10, s[32:35], s77 offen lds
    buffer_load_dwordx4 v11, s[32:35], s77 offen offset:1024 lds
    ds_read_b64_tr_b16 v[214:215], v132 offset:8192
    ds_read_b64_tr_b16 v[218:219], v133 offset:8192
    ds_read_b64_tr_b16 v[222:223], v134 offset:8192
    ds_read_b64_tr_b16 v[226:227], v135 offset:8192
    s_waitcnt vmcnt(6)
    s_lshl_b32 s77, s12, 5
    s_add_u32 m0, s72, 90112
    s_add_u32 s77, s77, s20
    buffer_load_dwordx4 v10, s[32:35], s77 offen lds
    buffer_load_dwordx4 v11, s[32:35], s77 offen offset:1024 lds
    ds_read_b64_tr_b16 v[228:229], v132 offset:49152
    ds_read_b64_tr_b16 v[232:233], v133 offset:49152
    ds_read_b64_tr_b16 v[236:237], v134 offset:49152
    ds_read_b64_tr_b16 v[240:241], v135 offset:49152
    ds_read_b64_tr_b16 v[230:231], v132 offset:57344
    ds_read_b64_tr_b16 v[234:235], v133 offset:57344
    ds_read_b64_tr_b16 v[238:239], v134 offset:57344
    ds_read_b64_tr_b16 v[242:243], v135 offset:57344
    s_waitcnt lgkmcnt(8)
    v_xor_b32 v253, 64, v254
    s_waitcnt lgkmcnt(0)
    s_mov_b32 s85, 0
L_spholdA:
    ds_read_b32 v21, v255 offset:64
    s_add_u32 s85, s85, 1
    s_waitcnt lgkmcnt(0)
    v_cmp_ne_u32 vcc, 1, v21
    s_cmp_gt_u32 s85, 0x40000
    s_cbranch_scc1 L_sdholdA
    s_cbranch_vccnz L_spholdA
L_sdholdA:
    s_lshl_b32 s77, s53, 2
    s_add_u32 s77, s77, 162400
    v_mov_b32 v22, s77
    v_mov_b32 v23, 1
    s_lshl_b32 s77, s13, 5
    s_add_u32 m0, s72, 122880
    s_add_u32 s77, s77, s19
    buffer_load_dwordx4 v10, s[32:35], s77 offen lds
    buffer_load_dwordx4 v11, s[32:35], s77 offen offset:1024 lds
    s_waitcnt vmcnt(8)
    s_lshl_b32 s77, s13, 5
    s_add_u32 m0, s72, 131072
    s_add_u32 s77, s77, s20
    buffer_load_dwordx4 v10, s[32:35], s77 offen lds
    buffer_load_dwordx4 v11, s[32:35], s77 offen offset:1024 lds
    s_waitcnt vmcnt(8)
    s_lshl_b32 s77, s14, 5
    s_add_u32 m0, s72, 139264
    s_add_u32 s77, s77, s19
    buffer_load_dwordx4 v10, s[32:35], s77 offen lds
    buffer_load_dwordx4 v11, s[32:35], s77 offen offset:1024 lds
    s_waitcnt vmcnt(8)
    s_lshl_b32 s77, s14, 5
    s_add_u32 m0, s72, 32768
    s_add_u32 s77, s77, s20
    buffer_load_dwordx4 v10, s[32:35], s77 offen lds
    buffer_load_dwordx4 v11, s[32:35], s77 offen offset:1024 lds
    s_waitcnt vmcnt(8)
    s_lshl_b32 s77, s15, 5
    s_add_u32 m0, s72, 40960
    s_add_u32 s77, s77, s21
    buffer_load_dwordx4 v10, s[36:39], s77 offen lds
    buffer_load_dwordx4 v11, s[36:39], s77 offen offset:1024 lds
    s_waitcnt vmcnt(8)
    s_lshl_b32 s77, s15, 5
    s_add_u32 m0, s72, 98304
    s_add_u32 s77, s77, s22
    buffer_load_dwordx4 v10, s[36:39], s77 offen lds
    buffer_load_dwordx4 v11, s[36:39], s77 offen offset:1024 lds
    s_waitcnt vmcnt(8)
    s_lshl_b32 s77, s16, 5
    s_add_u32 m0, s72, 106496
    s_add_u32 s77, s77, s21
    buffer_load_dwordx4 v10, s[36:39], s77 offen lds
    buffer_load_dwordx4 v11, s[36:39], s77 offen offset:1024 lds
    s_waitcnt vmcnt(8)
    s_lshl_b32 s77, s16, 5
    s_add_u32 m0, s72, 114688
    s_add_u32 s77, s77, s22
    buffer_load_dwordx4 v10, s[36:39], s77 offen lds
    buffer_load_dwordx4 v11, s[36:39], s77 offen offset:1024 lds
    ds_write_b32 v22, v23
    s_waitcnt vmcnt(8)
    s_lshl_b32 s77, s17, 5
    s_add_u32 m0, s72, 0
    s_add_u32 s77, s77, s21
    buffer_load_dwordx4 v10, s[36:39], s77 offen lds
    buffer_load_dwordx4 v11, s[36:39], s77 offen offset:1024 lds
    s_waitcnt vmcnt(8)
    s_lshl_b32 s77, s17, 5
    s_add_u32 m0, s72, 8192
    s_add_u32 s77, s77, s22
    buffer_load_dwordx4 v10, s[36:39], s77 offen lds
    buffer_load_dwordx4 v11, s[36:39], s77 offen offset:1024 lds
    s_waitcnt vmcnt(8)
    s_lshl_b32 s77, s18, 5
    s_add_u32 m0, s72, 49152
    s_add_u32 s77, s77, s21
    buffer_load_dwordx4 v10, s[36:39], s77 offen lds
    buffer_load_dwordx4 v11, s[36:39], s77 offen offset:1024 lds
    s_waitcnt vmcnt(8)
    s_lshl_b32 s77, s18, 5
    s_add_u32 m0, s72, 57344
    s_add_u32 s77, s77, s22
    buffer_load_dwordx4 v10, s[36:39], s77 offen lds
    buffer_load_dwordx4 v11, s[36:39], s77 offen offset:1024 lds
    s_mov_b32 s85, 0
L_sphold2A:
    ds_read_b32 v21, v255 offset:112
    s_add_u32 s85, s85, 1
    s_waitcnt lgkmcnt(0)
    v_cmp_ne_u32 vcc, 1, v21
    s_cmp_gt_u32 s85, 0x40000
    s_cbranch_scc1 L_sdhold2A
    s_cbranch_vccnz L_sphold2A
L_sdhold2A:
    buffer_load_dword v251, v250, s[40:43], s54 offen offset:2048 sc1
    s_waitcnt vmcnt(0)
    v_cmp_ne_u32 vcc, s61, v251
    s_cbranch_vccz L_pok0A
    s_mov_b32 s85, 0
L_spp0A:
    buffer_load_dword v251, v250, s[40:43], s54 offen offset:2048 sc1
    s_add_u32 s85, s85, 1
    s_waitcnt vmcnt(0)
    v_cmp_ne_u32 vcc, s61, v251
    s_cmp_gt_u32 s85, 0x8000
    s_cbranch_scc1 L_sdp0A
    s_cbranch_vccz L_sdp0A
    s_sleep 2
    s_branch L_spp0A
L_sdp0A:
L_pok0A:
    s_setprio 1
    buffer_load_dwordx4 v[244:247], v18, s[24:27], s3 offen
    s_add_u32 s77, s75, s4
    buffer_load_dwordx4 v[84:87], v1, s[40:43], s77 offen sc1
    buffer_load_dwordx4 v[88:91], v248, s[40:43], s77 offen sc1
    buffer_load_dwordx4 v[92:95], v12, s[40:43], s77 offen sc1
    buffer_load_dwordx4 v[96:99], v13, s[40:43], s77 offen sc1
    s_add_u32 s77, s75, s5
    buffer_load_dwordx4 v[100:103], v1, s[40:43], s77 offen sc1
    buffer_load_dwordx4 v[104:107], v248, s[40:43], s77 offen sc1
    buffer_load_dwordx4 v[108:111], v12, s[40:43], s77 offen sc1
    buffer_load_dwordx4 v[112:115], v13, s[40:43], s77 offen sc1
    s_add_u32 s77, s75, s6
    buffer_load_dwordx4 v[116:119], v1, s[40:43], s77 offen sc1
    buffer_load_dwordx4 v[120:123], v248, s[40:43], s77 offen sc1
    s_waitcnt vmcnt(9)
    v_mfma_f32_16x16x32_bf16 v[20:23], v[148:151], v[84:87], 0
    v_mfma_f32_16x16x32_bf16 v[24:27], v[152:155], v[84:87], 0
    v_mfma_f32_16x16x32_bf16 v[28:31], v[156:159], v[84:87], 0
    buffer_load_dwordx4 v[124:127], v12, s[40:43], s77 offen sc1
    v_mfma_f32_16x16x32_bf16 v[32:35], v[160:163], v[84:87], 0
    s_waitcnt vmcnt(9)
    v_mfma_f32_16x16x32_bf16 v[48:51], v[160:163], v[88:91], 0
    v_mfma_f32_16x16x32_bf16 v[44:47], v[156:159], v[88:91], 0
    v_mfma_f32_16x16x32_bf16 v[40:43], v[152:155], v[88:91], 0
    buffer_load_dwordx4 v[128:131], v13, s[40:43], s77 offen sc1
    v_mfma_f32_16x16x32_bf16 v[36:39], v[148:151], v[88:91], 0
    s_waitcnt vmcnt(9)
    v_mfma_f32_16x16x32_bf16 v[52:55], v[148:151], v[92:95], 0
    v_mfma_f32_16x16x32_bf16 v[56:59], v[152:155], v[92:95], 0
    v_mfma_f32_16x16x32_bf16 v[60:63], v[156:159], v[92:95], 0
    v_mfma_f32_16x16x32_bf16 v[64:67], v[160:163], v[92:95], 0
    s_waitcnt vmcnt(8)
    v_mfma_f32_16x16x32_bf16 v[80:83], v[160:163], v[96:99], 0
    v_mfma_f32_16x16x32_bf16 v[76:79], v[156:159], v[96:99], 0
    v_mfma_f32_16x16x32_bf16 v[72:75], v[152:155], v[96:99], 0
    v_mfma_f32_16x16x32_bf16 v[68:71], v[148:151], v[96:99], 0
    s_waitcnt vmcnt(7)
    v_mfma_f32_16x16x32_bf16 v[20:23], v[164:167], v[100:103], v[20:23]
    s_add_u32 s77, s75, s7
    buffer_load_dwordx4 v[84:87], v1, s[40:43], s77 offen sc1
    v_mfma_f32_16x16x32_bf16 v[24:27], v[168:171], v[100:103], v[24:27]
    v_mfma_f32_16x16x32_bf16 v[28:31], v[172:175], v[100:103], v[28:31]
    buffer_load_dwordx4 v[88:91], v248, s[40:43], s77 offen sc1
    v_mfma_f32_16x16x32_bf16 v[32:35], v[176:179], v[100:103], v[32:35]
    s_waitcnt vmcnt(8)
    v_mfma_f32_16x16x32_bf16 v[48:51], v[176:179], v[104:107], v[48:51]
    buffer_load_dwordx4 v[92:95], v12, s[40:43], s77 offen sc1
    v_mfma_f32_16x16x32_bf16 v[44:47], v[172:175], v[104:107], v[44:47]
    v_mfma_f32_16x16x32_bf16 v[40:43], v[168:171], v[104:107], v[40:43]
    buffer_load_dwordx4 v[96:99], v13, s[40:43], s77 offen sc1
    v_mfma_f32_16x16x32_bf16 v[36:39], v[164:167], v[104:107], v[36:39]
    s_waitcnt vmcnt(9)
    v_mfma_f32_16x16x32_bf16 v[52:55], v[164:167], v[108:111], v[52:55]
    v_mfma_f32_16x16x32_bf16 v[56:59], v[168:171], v[108:111], v[56:59]
    v_mfma_f32_16x16x32_bf16 v[60:63], v[172:175], v[108:111], v[60:63]
    s_add_u32 s77, s75, s8
    buffer_load_dwordx4 v[148:151], v1, s[40:43], s77 offen sc1
    v_mfma_f32_16x16x32_bf16 v[64:67], v[176:179], v[108:111], v[64:67]
    s_waitcnt vmcnt(9)
    v_mfma_f32_16x16x32_bf16 v[80:83], v[176:179], v[112:115], v[80:83]
    v_mfma_f32_16x16x32_bf16 v[76:79], v[172:175], v[112:115], v[76:79]
    v_mfma_f32_16x16x32_bf16 v[72:75], v[168:171], v[112:115], v[72:75]
    buffer_load_dwordx4 v[152:155], v248, s[40:43], s77 offen sc1
    v_mfma_f32_16x16x32_bf16 v[68:71], v[164:167], v[112:115], v[68:71]
    s_waitcnt vmcnt(9)
    v_mfma_f32_16x16x32_bf16 v[20:23], v[180:183], v[116:119], v[20:23]
    v_mfma_f32_16x16x32_bf16 v[24:27], v[184:187], v[116:119], v[24:27]
    v_mfma_f32_16x16x32_bf16 v[28:31], v[188:191], v[116:119], v[28:31]
    buffer_load_dwordx4 v[156:159], v12, s[40:43], s77 offen sc1
    v_mfma_f32_16x16x32_bf16 v[32:35], v[192:195], v[116:119], v[32:35]
    s_waitcnt vmcnt(9)
    v_mfma_f32_16x16x32_bf16 v[48:51], v[192:195], v[120:123], v[48:51]
    v_mfma_f32_16x16x32_bf16 v[44:47], v[188:191], v[120:123], v[44:47]
    v_mfma_f32_16x16x32_bf16 v[40:43], v[184:187], v[120:123], v[40:43]
    buffer_load_dwordx4 v[160:163], v13, s[40:43], s77 offen sc1
    v_mfma_f32_16x16x32_bf16 v[36:39], v[180:183], v[120:123], v[36:39]
    s_waitcnt vmcnt(9)
    v_mfma_f32_16x16x32_bf16 v[52:55], v[180:183], v[124:127], v[52:55]
    v_mfma_f32_16x16x32_bf16 v[56:59], v[184:187], v[124:127], v[56:59]
    v_mfma_f32_16x16x32_bf16 v[60:63], v[188:191], v[124:127], v[60:63]
    s_add_u32 s77, s75, s9
    buffer_load_dwordx4 v[100:103], v1, s[40:43], s77 offen sc1
    v_mfma_f32_16x16x32_bf16 v[64:67], v[192:195], v[124:127], v[64:67]
    s_waitcnt vmcnt(9)
    v_mfma_f32_16x16x32_bf16 v[80:83], v[192:195], v[128:131], v[80:83]
    v_mfma_f32_16x16x32_bf16 v[76:79], v[188:191], v[128:131], v[76:79]
    v_mfma_f32_16x16x32_bf16 v[72:75], v[184:187], v[128:131], v[72:75]
    buffer_load_dwordx4 v[104:107], v248, s[40:43], s77 offen sc1
    v_mfma_f32_16x16x32_bf16 v[68:71], v[180:183], v[128:131], v[68:71]
    s_waitcnt vmcnt(9)
    v_mfma_f32_16x16x32_bf16 v[20:23], v[196:199], v[84:87], v[20:23]
    v_mfma_f32_16x16x32_bf16 v[24:27], v[200:203], v[84:87], v[24:27]
    v_mfma_f32_16x16x32_bf16 v[28:31], v[204:207], v[84:87], v[28:31]
    buffer_load_dwordx4 v[108:111], v12, s[40:43], s77 offen sc1
    v_mfma_f32_16x16x32_bf16 v[32:35], v[208:211], v[84:87], v[32:35]
    s_waitcnt vmcnt(9)
    v_mfma_f32_16x16x32_bf16 v[48:51], v[208:211], v[88:91], v[48:51]
    v_mfma_f32_16x16x32_bf16 v[44:47], v[204:207], v[88:91], v[44:47]
    v_mfma_f32_16x16x32_bf16 v[40:43], v[200:203], v[88:91], v[40:43]
    buffer_load_dwordx4 v[112:115], v13, s[40:43], s77 offen sc1
    v_mfma_f32_16x16x32_bf16 v[36:39], v[196:199], v[88:91], v[36:39]
    s_waitcnt vmcnt(9)
    v_mfma_f32_16x16x32_bf16 v[52:55], v[196:199], v[92:95], v[52:55]
    v_mfma_f32_16x16x32_bf16 v[56:59], v[200:203], v[92:95], v[56:59]
    v_mfma_f32_16x16x32_bf16 v[60:63], v[204:207], v[92:95], v[60:63]
    s_add_u32 s77, s75, s10
    buffer_load_dwordx4 v[164:167], v1, s[40:43], s77 offen sc1
    v_mfma_f32_16x16x32_bf16 v[64:67], v[208:211], v[92:95], v[64:67]
    s_waitcnt vmcnt(9)
    v_mfma_f32_16x16x32_bf16 v[80:83], v[208:211], v[96:99], v[80:83]
    v_mfma_f32_16x16x32_bf16 v[76:79], v[204:207], v[96:99], v[76:79]
    v_mfma_f32_16x16x32_bf16 v[72:75], v[200:203], v[96:99], v[72:75]
    buffer_load_dwordx4 v[168:171], v248, s[40:43], s77 offen sc1
    v_mfma_f32_16x16x32_bf16 v[68:71], v[196:199], v[96:99], v[68:71]
    s_waitcnt vmcnt(9)
    v_mfma_f32_16x16x32_bf16 v[20:23], v[212:215], v[148:151], v[20:23]
    v_mfma_f32_16x16x32_bf16 v[24:27], v[216:219], v[148:151], v[24:27]
    v_mfma_f32_16x16x32_bf16 v[28:31], v[220:223], v[148:151], v[28:31]
    buffer_load_dwordx4 v[172:175], v12, s[40:43], s77 offen sc1
    v_mfma_f32_16x16x32_bf16 v[32:35], v[224:227], v[148:151], v[32:35]
    s_waitcnt vmcnt(9)
    v_mfma_f32_16x16x32_bf16 v[48:51], v[224:227], v[152:155], v[48:51]
    v_mfma_f32_16x16x32_bf16 v[44:47], v[220:223], v[152:155], v[44:47]
    v_mfma_f32_16x16x32_bf16 v[40:43], v[216:219], v[152:155], v[40:43]
    buffer_load_dwordx4 v[176:179], v13, s[40:43], s77 offen sc1
    v_mfma_f32_16x16x32_bf16 v[36:39], v[212:215], v[152:155], v[36:39]
    s_waitcnt vmcnt(9)
    v_mfma_f32_16x16x32_bf16 v[52:55], v[212:215], v[156:159], v[52:55]
    v_mfma_f32_16x16x32_bf16 v[56:59], v[216:219], v[156:159], v[56:59]
    v_mfma_f32_16x16x32_bf16 v[60:63], v[220:223], v[156:159], v[60:63]
    s_add_u32 s77, s75, s11
    buffer_load_dwordx4 v[116:119], v1, s[40:43], s77 offen sc1
    v_mfma_f32_16x16x32_bf16 v[64:67], v[224:227], v[156:159], v[64:67]
    s_waitcnt vmcnt(9)
    v_mfma_f32_16x16x32_bf16 v[80:83], v[224:227], v[160:163], v[80:83]
    v_mfma_f32_16x16x32_bf16 v[76:79], v[220:223], v[160:163], v[76:79]
    v_mfma_f32_16x16x32_bf16 v[72:75], v[216:219], v[160:163], v[72:75]
    buffer_load_dwordx4 v[120:123], v248, s[40:43], s77 offen sc1
    v_mfma_f32_16x16x32_bf16 v[68:71], v[212:215], v[160:163], v[68:71]
    s_waitcnt vmcnt(9)
    v_mfma_f32_16x16x32_bf16 v[20:23], v[228:231], v[100:103], v[20:23]
    ds_read_b64_tr_b16 v[180:181], v136 offset:0
    v_mfma_f32_16x16x32_bf16 v[24:27], v[232:235], v[100:103], v[24:27]
    ds_read_b64_tr_b16 v[184:185], v137 offset:0
    v_mfma_f32_16x16x32_bf16 v[28:31], v[236:239], v[100:103], v[28:31]
    ds_read_b64_tr_b16 v[188:189], v138 offset:0
    buffer_load_dwordx4 v[124:127], v12, s[40:43], s77 offen sc1
    v_mfma_f32_16x16x32_bf16 v[32:35], v[240:243], v[100:103], v[32:35]
    s_waitcnt vmcnt(9)
    v_mfma_f32_16x16x32_bf16 v[48:51], v[240:243], v[104:107], v[48:51]
    ds_read_b64_tr_b16 v[192:193], v139 offset:0
    v_mfma_f32_16x16x32_bf16 v[44:47], v[236:239], v[104:107], v[44:47]
    ds_read_b64_tr_b16 v[182:183], v132 offset:16384
    v_mfma_f32_16x16x32_bf16 v[40:43], v[232:235], v[104:107], v[40:43]
    ds_read_b64_tr_b16 v[186:187], v133 offset:16384
    buffer_load_dwordx4 v[128:131], v13, s[40:43], s77 offen sc1
    v_mfma_f32_16x16x32_bf16 v[36:39], v[228:231], v[104:107], v[36:39]
    s_waitcnt vmcnt(9)
    v_mfma_f32_16x16x32_bf16 v[52:55], v[228:231], v[108:111], v[52:55]
    ds_read_b64_tr_b16 v[190:191], v134 offset:16384
    v_mfma_f32_16x16x32_bf16 v[56:59], v[232:235], v[108:111], v[56:59]
    ds_read_b64_tr_b16 v[194:195], v135 offset:16384
    v_mfma_f32_16x16x32_bf16 v[60:63], v[236:239], v[108:111], v[60:63]
    s_add_u32 s77, s75, s12
    buffer_load_dwordx4 v[84:87], v1, s[40:43], s77 offen sc1
    v_mfma_f32_16x16x32_bf16 v[64:67], v[240:243], v[108:111], v[64:67]
    s_waitcnt vmcnt(9)
    v_mfma_f32_16x16x32_bf16 v[80:83], v[240:243], v[112:115], v[80:83]
    v_mfma_f32_16x16x32_bf16 v[76:79], v[236:239], v[112:115], v[76:79]
    v_mfma_f32_16x16x32_bf16 v[72:75], v[232:235], v[112:115], v[72:75]
    buffer_load_dwordx4 v[88:91], v248, s[40:43], s77 offen sc1
    v_mfma_f32_16x16x32_bf16 v[68:71], v[228:231], v[112:115], v[68:71]
    s_waitcnt lgkmcnt(0)
    s_waitcnt vmcnt(9)
    v_mfma_f32_16x16x32_bf16 v[20:23], v[180:183], v[164:167], v[20:23]
    ds_read_b64_tr_b16 v[196:197], v132 offset:24576
    v_mfma_f32_16x16x32_bf16 v[24:27], v[184:187], v[164:167], v[24:27]
    ds_read_b64_tr_b16 v[200:201], v133 offset:24576
    v_mfma_f32_16x16x32_bf16 v[28:31], v[188:191], v[164:167], v[28:31]
    ds_read_b64_tr_b16 v[204:205], v134 offset:24576
    buffer_load_dwordx4 v[92:95], v12, s[40:43], s77 offen sc1
    v_mfma_f32_16x16x32_bf16 v[32:35], v[192:195], v[164:167], v[32:35]
    s_waitcnt vmcnt(9)
    v_mfma_f32_16x16x32_bf16 v[48:51], v[192:195], v[168:171], v[48:51]
    ds_read_b64_tr_b16 v[208:209], v135 offset:24576
    v_mfma_f32_16x16x32_bf16 v[44:47], v[188:191], v[168:171], v[44:47]
    ds_read_b64_tr_b16 v[198:199], v136 offset:8192
    v_mfma_f32_16x16x32_bf16 v[40:43], v[184:187], v[168:171], v[40:43]
    ds_read_b64_tr_b16 v[202:203], v137 offset:8192
    buffer_load_dwordx4 v[96:99], v13, s[40:43], s77 offen sc1
    v_mfma_f32_16x16x32_bf16 v[36:39], v[180:183], v[168:171], v[36:39]
    s_waitcnt vmcnt(9)
    v_mfma_f32_16x16x32_bf16 v[52:55], v[180:183], v[172:175], v[52:55]
    ds_read_b64_tr_b16 v[206:207], v138 offset:8192
    v_mfma_f32_16x16x32_bf16 v[56:59], v[184:187], v[172:175], v[56:59]
    ds_read_b64_tr_b16 v[210:211], v139 offset:8192
    v_mfma_f32_16x16x32_bf16 v[60:63], v[188:191], v[172:175], v[60:63]
    s_add_u32 s77, s75, s13
    buffer_load_dwordx4 v[148:151], v1, s[40:43], s77 offen sc1
    v_mfma_f32_16x16x32_bf16 v[64:67], v[192:195], v[172:175], v[64:67]
    s_waitcnt vmcnt(9)
    v_mfma_f32_16x16x32_bf16 v[80:83], v[192:195], v[176:179], v[80:83]
    v_mfma_f32_16x16x32_bf16 v[76:79], v[188:191], v[176:179], v[76:79]
    v_mfma_f32_16x16x32_bf16 v[72:75], v[184:187], v[176:179], v[72:75]
    buffer_load_dwordx4 v[152:155], v248, s[40:43], s77 offen sc1
    v_mfma_f32_16x16x32_bf16 v[68:71], v[180:183], v[176:179], v[68:71]
    s_waitcnt lgkmcnt(0)
    s_waitcnt vmcnt(9)
    v_mfma_f32_16x16x32_bf16 v[20:23], v[196:199], v[116:119], v[20:23]
    ds_read_b64_tr_b16 v[212:213], v136 offset:16384
    v_mfma_f32_16x16x32_bf16 v[24:27], v[200:203], v[116:119], v[24:27]
    ds_read_b64_tr_b16 v[216:217], v137 offset:16384
    v_mfma_f32_16x16x32_bf16 v[28:31], v[204:207], v[116:119], v[28:31]
    ds_read_b64_tr_b16 v[220:221], v138 offset:16384
    buffer_load_dwordx4 v[156:159], v12, s[40:43], s77 offen sc1
    v_mfma_f32_16x16x32_bf16 v[32:35], v[208:211], v[116:119], v[32:35]
    s_waitcnt vmcnt(9)
    v_mfma_f32_16x16x32_bf16 v[48:51], v[208:211], v[120:123], v[48:51]
    ds_read_b64_tr_b16 v[224:225], v139 offset:16384
    v_mfma_f32_16x16x32_bf16 v[44:47], v[204:207], v[120:123], v[44:47]
    ds_read_b64_tr_b16 v[214:215], v136 offset:24576
    v_mfma_f32_16x16x32_bf16 v[40:43], v[200:203], v[120:123], v[40:43]
    ds_read_b64_tr_b16 v[218:219], v137 offset:24576
    buffer_load_dwordx4 v[160:163], v13, s[40:43], s77 offen sc1
    buffer_load_dword v251, v249, s[40:43], s54 offen sc1
    v_mfma_f32_16x16x32_bf16 v[36:39], v[196:199], v[120:123], v[36:39]
    s_waitcnt vmcnt(10)
    v_mfma_f32_16x16x32_bf16 v[52:55], v[196:199], v[124:127], v[52:55]
    ds_read_b64_tr_b16 v[222:223], v138 offset:24576
    v_mfma_f32_16x16x32_bf16 v[56:59], v[200:203], v[124:127], v[56:59]
    ds_read_b64_tr_b16 v[226:227], v139 offset:24576
    v_mfma_f32_16x16x32_bf16 v[60:63], v[204:207], v[124:127], v[60:63]
    s_add_u32 s77, s75, s14
    buffer_load_dwordx4 v[100:103], v1, s[40:43], s77 offen sc1
    v_mfma_f32_16x16x32_bf16 v[64:67], v[208:211], v[124:127], v[64:67]
    s_waitcnt vmcnt(10)
    v_mfma_f32_16x16x32_bf16 v[80:83], v[208:211], v[128:131], v[80:83]
    v_mfma_f32_16x16x32_bf16 v[76:79], v[204:207], v[128:131], v[76:79]
    v_mfma_f32_16x16x32_bf16 v[72:75], v[200:203], v[128:131], v[72:75]
    buffer_load_dwordx4 v[104:107], v248, s[40:43], s77 offen sc1
    v_mfma_f32_16x16x32_bf16 v[68:71], v[196:199], v[128:131], v[68:71]
    s_waitcnt lgkmcnt(0)
    s_waitcnt vmcnt(10)
    v_mfma_f32_16x16x32_bf16 v[20:23], v[212:215], v[84:87], v[20:23]
    ds_read_b64_tr_b16 v[228:229], v136 offset:57344
    v_mfma_f32_16x16x32_bf16 v[24:27], v[216:219], v[84:87], v[24:27]
    ds_read_b64_tr_b16 v[232:233], v137 offset:57344
    v_mfma_f32_16x16x32_bf16 v[28:31], v[220:223], v[84:87], v[28:31]
    ds_read_b64_tr_b16 v[236:237], v138 offset:57344
    buffer_load_dwordx4 v[108:111], v12, s[40:43], s77 offen sc1
    v_mfma_f32_16x16x32_bf16 v[32:35], v[224:227], v[84:87], v[32:35]
    s_waitcnt vmcnt(10)
    v_mfma_f32_16x16x32_bf16 v[48:51], v[224:227], v[88:91], v[48:51]
    ds_read_b64_tr_b16 v[240:241], v139 offset:57344
    v_mfma_f32_16x16x32_bf16 v[44:47], v[220:223], v[88:91], v[44:47]
    ds_read_b64_tr_b16 v[230:231], v140 offset:0
    v_mfma_f32_16x16x32_bf16 v[40:43], v[216:219], v[88:91], v[40:43]
    ds_read_b64_tr_b16 v[234:235], v141 offset:0
    buffer_load_dwordx4 v[112:115], v13, s[40:43], s77 offen sc1
    v_mfma_f32_16x16x32_bf16 v[36:39], v[212:215], v[88:91], v[36:39]
    s_waitcnt vmcnt(10)
    v_mfma_f32_16x16x32_bf16 v[52:55], v[212:215], v[92:95], v[52:55]
    ds_read_b64_tr_b16 v[238:239], v142 offset:0
    v_mfma_f32_16x16x32_bf16 v[56:59], v[216:219], v[92:95], v[56:59]
    ds_read_b64_tr_b16 v[242:243], v143 offset:0
    v_mfma_f32_16x16x32_bf16 v[60:63], v[220:223], v[92:95], v[60:63]
    s_waitcnt vmcnt(4)
    v_cmp_ne_u32 vcc, s61, v251
    s_cbranch_vccz L_pok11A
    s_mov_b32 s85, 0
L_spp11A:
    buffer_load_dword v251, v249, s[40:43], s54 offen sc1
    s_add_u32 s85, s85, 1
    s_waitcnt vmcnt(0)
    v_cmp_ne_u32 vcc, s61, v251
    s_cmp_gt_u32 s85, 0x8000
    s_cbranch_scc1 L_sdp11A
    s_cbranch_vccz L_sdp11A
    s_sleep 2
    s_branch L_spp11A
L_sdp11A:
L_pok11A:
    s_add_u32 s77, s75, s15
    buffer_load_dwordx4 v[164:167], v1, s[40:43], s77 offen sc1
    v_mfma_f32_16x16x32_bf16 v[64:67], v[224:227], v[92:95], v[64:67]
    v_mfma_f32_16x16x32_bf16 v[80:83], v[224:227], v[96:99], v[80:83]
    v_mfma_f32_16x16x32_bf16 v[76:79], v[220:223], v[96:99], v[76:79]
    v_mfma_f32_16x16x32_bf16 v[72:75], v[216:219], v[96:99], v[72:75]
    buffer_load_dwordx4 v[168:171], v248, s[40:43], s77 offen sc1
    v_mfma_f32_16x16x32_bf16 v[68:71], v[212:215], v[96:99], v[68:71]
    s_waitcnt lgkmcnt(0)
    v_mfma_f32_16x16x32_bf16 v[20:23], v[228:231], v[148:151], v[20:23]
    ds_read_b64_tr_b16 v[180:181], v140 offset:8192
    v_mfma_f32_16x16x32_bf16 v[24:27], v[232:235], v[148:151], v[24:27]
    ds_read_b64_tr_b16 v[184:185], v141 offset:8192
    v_mfma_f32_16x16x32_bf16 v[28:31], v[236:239], v[148:151], v[28:31]
    ds_read_b64_tr_b16 v[188:189], v142 offset:8192
    buffer_load_dwordx4 v[172:175], v12, s[40:43], s77 offen sc1
    v_mfma_f32_16x16x32_bf16 v[32:35], v[240:243], v[148:151], v[32:35]
    v_mfma_f32_16x16x32_bf16 v[48:51], v[240:243], v[152:155], v[48:51]
    ds_read_b64_tr_b16 v[192:193], v143 offset:8192
    v_mfma_f32_16x16x32_bf16 v[44:47], v[236:239], v[152:155], v[44:47]
    ds_read_b64_tr_b16 v[182:183], v132 offset:32768
    v_mfma_f32_16x16x32_bf16 v[40:43], v[232:235], v[152:155], v[40:43]
    ds_read_b64_tr_b16 v[186:187], v133 offset:32768
    buffer_load_dwordx4 v[176:179], v13, s[40:43], s77 offen sc1
    v_mfma_f32_16x16x32_bf16 v[36:39], v[228:231], v[152:155], v[36:39]
    v_mfma_f32_16x16x32_bf16 v[52:55], v[228:231], v[156:159], v[52:55]
    ds_read_b64_tr_b16 v[190:191], v134 offset:32768
    v_mfma_f32_16x16x32_bf16 v[56:59], v[232:235], v[156:159], v[56:59]
    ds_read_b64_tr_b16 v[194:195], v135 offset:32768
    v_mfma_f32_16x16x32_bf16 v[60:63], v[236:239], v[156:159], v[60:63]
    s_add_u32 s77, s75, s16
    buffer_load_dwordx4 v[116:119], v1, s[40:43], s77 offen sc1
    v_mfma_f32_16x16x32_bf16 v[64:67], v[240:243], v[156:159], v[64:67]
    v_mfma_f32_16x16x32_bf16 v[80:83], v[240:243], v[160:163], v[80:83]
    v_mfma_f32_16x16x32_bf16 v[76:79], v[236:239], v[160:163], v[76:79]
    v_mfma_f32_16x16x32_bf16 v[72:75], v[232:235], v[160:163], v[72:75]
    buffer_load_dwordx4 v[120:123], v248, s[40:43], s77 offen sc1
    v_mfma_f32_16x16x32_bf16 v[68:71], v[228:231], v[160:163], v[68:71]
    s_waitcnt lgkmcnt(0)
    s_waitcnt vmcnt(9)
    v_mfma_f32_16x16x32_bf16 v[20:23], v[180:183], v[100:103], v[20:23]
    ds_read_b64_tr_b16 v[196:197], v132 offset:40960
    v_mfma_f32_16x16x32_bf16 v[24:27], v[184:187], v[100:103], v[24:27]
    ds_read_b64_tr_b16 v[200:201], v133 offset:40960
    v_mfma_f32_16x16x32_bf16 v[28:31], v[188:191], v[100:103], v[28:31]
    ds_read_b64_tr_b16 v[204:205], v134 offset:40960
    buffer_load_dwordx4 v[124:127], v12, s[40:43], s77 offen sc1
    v_mfma_f32_16x16x32_bf16 v[32:35], v[192:195], v[100:103], v[32:35]
    s_waitcnt vmcnt(9)
    v_mfma_f32_16x16x32_bf16 v[48:51], v[192:195], v[104:107], v[48:51]
    ds_read_b64_tr_b16 v[208:209], v135 offset:40960
    v_mfma_f32_16x16x32_bf16 v[44:47], v[188:191], v[104:107], v[44:47]
    ds_read_b64_tr_b16 v[198:199], v136 offset:32768
    v_mfma_f32_16x16x32_bf16 v[40:43], v[184:187], v[104:107], v[40:43]
    ds_read_b64_tr_b16 v[202:203], v137 offset:32768
    buffer_load_dwordx4 v[128:131], v13, s[40:43], s77 offen sc1
    v_mfma_f32_16x16x32_bf16 v[36:39], v[180:183], v[104:107], v[36:39]
    s_waitcnt vmcnt(9)
    v_mfma_f32_16x16x32_bf16 v[52:55], v[180:183], v[108:111], v[52:55]
    ds_read_b64_tr_b16 v[206:207], v138 offset:32768
    v_mfma_f32_16x16x32_bf16 v[56:59], v[184:187], v[108:111], v[56:59]
    ds_read_b64_tr_b16 v[210:211], v139 offset:32768
    v_mfma_f32_16x16x32_bf16 v[60:63], v[188:191], v[108:111], v[60:63]
    s_add_u32 s77, s75, s17
    buffer_load_dwordx4 v[84:87], v1, s[40:43], s77 offen sc1
    v_mfma_f32_16x16x32_bf16 v[64:67], v[192:195], v[108:111], v[64:67]
    s_waitcnt vmcnt(9)
    v_mfma_f32_16x16x32_bf16 v[80:83], v[192:195], v[112:115], v[80:83]
    v_mfma_f32_16x16x32_bf16 v[76:79], v[188:191], v[112:115], v[76:79]
    v_mfma_f32_16x16x32_bf16 v[72:75], v[184:187], v[112:115], v[72:75]
    buffer_load_dwordx4 v[88:91], v248, s[40:43], s77 offen sc1
    v_mfma_f32_16x16x32_bf16 v[68:71], v[180:183], v[112:115], v[68:71]
    s_waitcnt lgkmcnt(0)
    s_waitcnt vmcnt(9)
    v_mfma_f32_16x16x32_bf16 v[20:23], v[196:199], v[164:167], v[20:23]
    ds_read_b64_tr_b16 v[212:213], v136 offset:40960
    v_mfma_f32_16x16x32_bf16 v[24:27], v[200:203], v[164:167], v[24:27]
    ds_read_b64_tr_b16 v[216:217], v137 offset:40960
    v_mfma_f32_16x16x32_bf16 v[28:31], v[204:207], v[164:167], v[28:31]
    ds_read_b64_tr_b16 v[220:221], v138 offset:40960
    buffer_load_dwordx4 v[92:95], v12, s[40:43], s77 offen sc1
    v_mfma_f32_16x16x32_bf16 v[32:35], v[208:211], v[164:167], v[32:35]
    s_waitcnt vmcnt(9)
    v_mfma_f32_16x16x32_bf16 v[48:51], v[208:211], v[168:171], v[48:51]
    ds_read_b64_tr_b16 v[224:225], v139 offset:40960
    v_mfma_f32_16x16x32_bf16 v[44:47], v[204:207], v[168:171], v[44:47]
    ds_read_b64_tr_b16 v[214:215], v136 offset:49152
    v_mfma_f32_16x16x32_bf16 v[40:43], v[200:203], v[168:171], v[40:43]
    ds_read_b64_tr_b16 v[218:219], v137 offset:49152
    buffer_load_dwordx4 v[96:99], v13, s[40:43], s77 offen sc1
    v_mfma_f32_16x16x32_bf16 v[36:39], v[196:199], v[168:171], v[36:39]
    s_waitcnt vmcnt(9)
    v_mfma_f32_16x16x32_bf16 v[52:55], v[196:199], v[172:175], v[52:55]
    ds_read_b64_tr_b16 v[222:223], v138 offset:49152
    v_mfma_f32_16x16x32_bf16 v[56:59], v[200:203], v[172:175], v[56:59]
    ds_read_b64_tr_b16 v[226:227], v139 offset:49152
    v_mfma_f32_16x16x32_bf16 v[60:63], v[204:207], v[172:175], v[60:63]
    s_add_u32 s77, s75, s18
    buffer_load_dwordx4 v[148:151], v1, s[40:43], s77 offen sc1
    v_mfma_f32_16x16x32_bf16 v[64:67], v[208:211], v[172:175], v[64:67]
    s_waitcnt vmcnt(9)
    v_mfma_f32_16x16x32_bf16 v[80:83], v[208:211], v[176:179], v[80:83]
    v_mfma_f32_16x16x32_bf16 v[76:79], v[204:207], v[176:179], v[76:79]
    v_mfma_f32_16x16x32_bf16 v[72:75], v[200:203], v[176:179], v[72:75]
    buffer_load_dwordx4 v[152:155], v248, s[40:43], s77 offen sc1
    v_mfma_f32_16x16x32_bf16 v[68:71], v[196:199], v[176:179], v[68:71]
    s_waitcnt lgkmcnt(0)
    s_waitcnt vmcnt(9)
    v_mfma_f32_16x16x32_bf16 v[20:23], v[212:215], v[116:119], v[20:23]
    ds_read_b64_tr_b16 v[228:229], v132 offset:0
    v_mfma_f32_16x16x32_bf16 v[24:27], v[216:219], v[116:119], v[24:27]
    ds_read_b64_tr_b16 v[232:233], v133 offset:0
    v_mfma_f32_16x16x32_bf16 v[28:31], v[220:223], v[116:119], v[28:31]
    ds_read_b64_tr_b16 v[236:237], v134 offset:0
    buffer_load_dwordx4 v[156:159], v12, s[40:43], s77 offen sc1
    v_mfma_f32_16x16x32_bf16 v[32:35], v[224:227], v[116:119], v[32:35]
    s_waitcnt vmcnt(9)
    v_mfma_f32_16x16x32_bf16 v[48:51], v[224:227], v[120:123], v[48:51]
    ds_read_b64_tr_b16 v[240:241], v135 offset:0
    v_mfma_f32_16x16x32_bf16 v[44:47], v[220:223], v[120:123], v[44:47]
    ds_read_b64_tr_b16 v[230:231], v132 offset:8192
    v_mfma_f32_16x16x32_bf16 v[40:43], v[216:219], v[120:123], v[40:43]
    ds_read_b64_tr_b16 v[234:235], v133 offset:8192
    buffer_load_dwordx4 v[160:163], v13, s[40:43], s77 offen sc1
    v_mfma_f32_16x16x32_bf16 v[36:39], v[212:215], v[120:123], v[36:39]
    s_waitcnt vmcnt(9)
    v_mfma_f32_16x16x32_bf16 v[52:55], v[212:215], v[124:127], v[52:55]
    ds_read_b64_tr_b16 v[238:239], v134 offset:8192
    v_mfma_f32_16x16x32_bf16 v[56:59], v[216:219], v[124:127], v[56:59]
    ds_read_b64_tr_b16 v[242:243], v135 offset:8192
    v_mfma_f32_16x16x32_bf16 v[60:63], v[220:223], v[124:127], v[60:63]
    v_mfma_f32_16x16x32_bf16 v[64:67], v[224:227], v[124:127], v[64:67]
    s_waitcnt vmcnt(8)
    v_mfma_f32_16x16x32_bf16 v[80:83], v[224:227], v[128:131], v[80:83]
    v_mfma_f32_16x16x32_bf16 v[76:79], v[220:223], v[128:131], v[76:79]
    v_mfma_f32_16x16x32_bf16 v[72:75], v[216:219], v[128:131], v[72:75]
    v_mfma_f32_16x16x32_bf16 v[68:71], v[212:215], v[128:131], v[68:71]
    s_waitcnt lgkmcnt(0)
    s_waitcnt vmcnt(7)
    v_mfma_f32_16x16x32_bf16 v[20:23], v[228:231], v[84:87], v[20:23]
    ds_read_b64_tr_b16 v[100:101], v132 offset:49152
    v_mfma_f32_16x16x32_bf16 v[24:27], v[232:235], v[84:87], v[24:27]
    ds_read_b64_tr_b16 v[104:105], v133 offset:49152
    v_mfma_f32_16x16x32_bf16 v[28:31], v[236:239], v[84:87], v[28:31]
    ds_read_b64_tr_b16 v[108:109], v134 offset:49152
    v_mfma_f32_16x16x32_bf16 v[32:35], v[240:243], v[84:87], v[32:35]
    s_waitcnt vmcnt(6)
    v_mfma_f32_16x16x32_bf16 v[48:51], v[240:243], v[88:91], v[48:51]
    ds_read_b64_tr_b16 v[112:113], v135 offset:49152
    v_mfma_f32_16x16x32_bf16 v[44:47], v[236:239], v[88:91], v[44:47]
    ds_read_b64_tr_b16 v[102:103], v132 offset:57344
    v_mfma_f32_16x16x32_bf16 v[40:43], v[232:235], v[88:91], v[40:43]
    ds_read_b64_tr_b16 v[106:107], v133 offset:57344
    v_mfma_f32_16x16x32_bf16 v[36:39], v[228:231], v[88:91], v[36:39]
    s_waitcnt vmcnt(5)
    v_mfma_f32_16x16x32_bf16 v[52:55], v[228:231], v[92:95], v[52:55]
    ds_read_b64_tr_b16 v[110:111], v134 offset:57344
    v_mfma_f32_16x16x32_bf16 v[56:59], v[232:235], v[92:95], v[56:59]
    ds_read_b64_tr_b16 v[114:115], v135 offset:57344
    v_mfma_f32_16x16x32_bf16 v[60:63], v[236:239], v[92:95], v[60:63]
    v_mfma_f32_16x16x32_bf16 v[64:67], v[240:243], v[92:95], v[64:67]
    s_waitcnt vmcnt(4)
    v_mfma_f32_16x16x32_bf16 v[80:83], v[240:243], v[96:99], v[80:83]
    v_mfma_f32_16x16x32_bf16 v[76:79], v[236:239], v[96:99], v[76:79]
    v_mfma_f32_16x16x32_bf16 v[72:75], v[232:235], v[96:99], v[72:75]
    v_mfma_f32_16x16x32_bf16 v[68:71], v[228:231], v[96:99], v[68:71]
    s_waitcnt lgkmcnt(0)
    s_waitcnt vmcnt(3)
    v_mfma_f32_16x16x32_bf16 v[20:23], v[100:103], v[148:151], v[20:23]
    v_mfma_f32_16x16x32_bf16 v[24:27], v[104:107], v[148:151], v[24:27]
    v_mfma_f32_16x16x32_bf16 v[28:31], v[108:111], v[148:151], v[28:31]
    v_mfma_f32_16x16x32_bf16 v[32:35], v[112:115], v[148:151], v[32:35]
    s_waitcnt vmcnt(2)
    v_mfma_f32_16x16x32_bf16 v[48:51], v[112:115], v[152:155], v[48:51]
    v_mfma_f32_16x16x32_bf16 v[44:47], v[108:111], v[152:155], v[44:47]
    v_mfma_f32_16x16x32_bf16 v[40:43], v[104:107], v[152:155], v[40:43]
    v_mfma_f32_16x16x32_bf16 v[36:39], v[100:103], v[152:155], v[36:39]
    s_waitcnt vmcnt(1)
    v_mfma_f32_16x16x32_bf16 v[52:55], v[100:103], v[156:159], v[52:55]
    v_mfma_f32_16x16x32_bf16 v[56:59], v[104:107], v[156:159], v[56:59]
    ds_write_b128 v254, v[20:23] offset:0
    v_mfma_f32_16x16x32_bf16 v[60:63], v[108:111], v[156:159], v[60:63]
    ds_write_b128 v253, v[24:27] offset:0
    v_mfma_f32_16x16x32_bf16 v[64:67], v[112:115], v[156:159], v[64:67]
    ds_write_b128 v254, v[28:31] offset:128
    s_waitcnt vmcnt(0)
    v_mfma_f32_16x16x32_bf16 v[80:83], v[112:115], v[160:163], v[80:83]
    ds_write_b128 v253, v[32:35] offset:128
    v_mfma_f32_16x16x32_bf16 v[76:79], v[108:111], v[160:163], v[76:79]
    ds_write_b128 v253, v[48:51] offset:16512
    v_mfma_f32_16x16x32_bf16 v[72:75], v[104:107], v[160:163], v[72:75]
    ds_write_b128 v254, v[44:47] offset:16512
    v_mfma_f32_16x16x32_bf16 v[68:71], v[100:103], v[160:163], v[68:71]
    ds_write_b128 v253, v[40:43] offset:16384
    ds_write_b128 v254, v[36:39] offset:16384
    ds_write_b128 v254, v[52:55] offset:32768
    ds_write_b128 v253, v[56:59] offset:32768
    ds_write_b128 v254, v[60:63] offset:32896
    ds_write_b128 v253, v[64:67] offset:32896
    ds_write_b128 v253, v[80:83] offset:49280
    ds_write_b128 v254, v[76:79] offset:49280
    ds_write_b128 v253, v[72:75] offset:49152
    ds_write_b128 v254, v[68:71] offset:49152
    s_branch L_final
L_C:
    s_waitcnt lgkmcnt(0)
    s_load_dword s61, s[22:23], 0
    s_mov_b32 s24, s4
    s_mov_b32 s25, s5
    s_mov_b32 s26, 2097152
    s_mov_b32 s27, 0x20000
    s_lshl4_add_u32 s77, s55, s56
    s_lshl2_add_u32 s82, s77, s52
    s_lshl_b32 s77, s82, 11
    buffer_load_dwordx4 v[164:167], v1, s[24:27], s77 offen
    buffer_load_dwordx4 v[168:171], v1, s[24:27], s77 offen offset:1024
    s_lshl_b32 s84, s82, 5
    s_add_u32 s84, s84, 4096
    s_mov_b32 s48, s14
    s_mov_b32 s49, s15
    s_mov_b32 s50, 2752
    s_mov_b32 s51, 0x20000
    v_lshl_add_u32 v173, s52, 6, v0
    v_lshlrev_b32 v163, 1, v173
    s_lshl_b32 s77, s76, 6
    s_cmp_lt_u32 s56, 8
    s_cselect_b32 s77, 1073741824, s77
    buffer_load_ushort v172, v163, s[48:51], s77 offen
    s_and_b32 s53, s52, 1
    s_lshr_b32 s54, s52, 1
    v_and_b32 v222, 15, v0
    v_lshrrev_b32 v223, 4, v0
    v_lshrrev_b32 v224, 1, v222
    v_xor_b32 v224, v224, v223
    s_lshl_b32 s80, s53, 13
    v_lshlrev_b32 v225, 7, v222
    v_lshl_add_u32 v225, v224, 4, v225
    v_add_u32 v2, s80, v225
    v_xor_b32 v3, 64, v2
    v_and_b32 v224, 3, v0
    v_lshlrev_b32 v224, 3, v224
    v_bfe_u32 v225, v0, 3, 1
    v_xor_b32 v225, s54, v225
    v_lshl_add_u32 v224, v225, 6, v224
    v_and_b32 v226, 1, v223
    v_lshl_add_u32 v224, v226, 5, v224
    v_bfe_u32 v225, v0, 2, 2
    v_lshl_add_u32 v224, v225, 7, v224
    v_mul_u32_u24 v225, 3072, v223
    v_add_u32 v224, v224, v225
    v_add_u32 v4, 49152, v224
    v_xor_b32 v5, 32, v4
    s_lshl_b32 s77, s53, 8
    s_add_u32 s77, s77, 161280
    v_lshl_add_u32 v239, v223, 4, s77
    v_lshl_add_u32 v243, v222, 2, s77
    s_lshl_b32 s77, s54, 7
    s_add_u32 s77, s77, 159744
    v_lshl_add_u32 v242, v222, 2, s77
    v_lshl_add_u32 v238, v223, 4, s77
    s_and_b32 s77, s2, 7
    s_lshr_b32 s78, s2, 3
    s_and_b32 s58, s78, 7
    s_lshr_b32 s78, s78, 3
    s_xor_b32 s78, s78, 2
    s_and_b32 s60, s58, 1
    s_lshl1_add_u32 s60, s78, s60
    s_lshr_b32 s78, s58, 1
    s_mov_b32 s58, s60
    s_lshr_b32 s59, s77, 1
    s_and_b32 s77, s77, 1
    s_lshl2_add_u32 s77, s77, s59
    s_lshl2_add_u32 s59, s77, s78
    s_lshl1_add_u32 s60, s78, s58
    s_mov_b32 s40, s22
    s_mov_b32 s41, s23
    s_mov_b32 s42, 16777216
    s_mov_b32 s43, 0x20000
    s_mov_b32 s44, s18
    s_mov_b32 s45, s19
    s_mov_b32 s46, 2097152
    s_mov_b32 s47, 0x20000
    s_lshl1_add_u32 s77, s55, s53
    s_mul_i32 s75, s77, 245760
    s_add_u32 s75, s75, 2097152
    s_lshl4_add_u32 s77, s77, s56
    s_lshl1_add_u32 s77, s77, s54
    s_lshl_b32 s64, s77, 7
    s_add_u32 s64, s64, 1048576
    v_add_u32 v248, 61440, v1
    v_add_u32 v16, 122880, v1
    v_add_u32 v255, 184320, v1
    v_mov_b32 v220, 0.5
    v_mov_b32 v224, 0x3f317218
    v_mov_b32 v226, 1.0
    v_mov_b32 v228, 0x358637bd
    s_lshl_b32 s77, s52, 2
    s_add_u32 s77, s77, 162304
    v_mov_b32 v14, s77
    v_mov_b32 v15, 1
    s_waitcnt vmcnt(1) lgkmcnt(0)
    s_mul_i32 s61, s61, 0x9e3779b1
    s_add_u32 s61, s61, 0x7f4a7c15
    v_lshlrev_b32 v116, 16, v164
    v_and_b32 v117, 0xffff0000, v164
    v_lshlrev_b32 v118, 16, v165
    v_and_b32 v119, 0xffff0000, v165
    v_lshlrev_b32 v120, 16, v166
    v_and_b32 v121, 0xffff0000, v166
    v_lshlrev_b32 v122, 16, v167
    v_and_b32 v123, 0xffff0000, v167
    v_lshlrev_b32 v124, 16, v168
    v_and_b32 v125, 0xffff0000, v168
    v_lshlrev_b32 v126, 16, v169
    v_and_b32 v127, 0xffff0000, v169
    v_lshlrev_b32 v128, 16, v170
    v_and_b32 v129, 0xffff0000, v170
    v_lshlrev_b32 v130, 16, v171
    v_and_b32 v131, 0xffff0000, v171
    v_add_f32 v132, v116, v117
    v_add_f32 v133, v124, v125
    v_add_f32 v132, v132, v118
    v_add_f32 v133, v133, v126
    v_add_f32 v132, v132, v119
    v_add_f32 v133, v133, v127
    v_add_f32 v132, v132, v120
    v_add_f32 v133, v133, v128
    v_add_f32 v132, v132, v121
    v_add_f32 v133, v133, v129
    v_add_f32 v132, v132, v122
    v_add_f32 v133, v133, v130
    v_add_f32 v132, v132, v123
    v_add_f32 v133, v133, v131
    s_nop 0
    v_add_f32_dpp v132, v132, v132 quad_perm:[1,0,3,2] row_mask:0xf bank_mask:0xf
    v_add_f32_dpp v133, v133, v133 quad_perm:[1,0,3,2] row_mask:0xf bank_mask:0xf
    s_nop 0
    v_add_f32_dpp v132, v132, v132 quad_perm:[2,3,0,1] row_mask:0xf bank_mask:0xf
    v_add_f32_dpp v133, v133, v133 quad_perm:[2,3,0,1] row_mask:0xf bank_mask:0xf
    s_nop 0
    v_add_f32_dpp v132, v132, v132 row_half_mirror row_mask:0xf bank_mask:0xf
    v_add_f32_dpp v133, v133, v133 row_half_mirror row_mask:0xf bank_mask:0xf
    s_nop 0
    v_add_f32_dpp v132, v132, v132 row_mirror row_mask:0xf bank_mask:0xf
    v_add_f32_dpp v133, v133, v133 row_mirror row_mask:0xf bank_mask:0xf
    v_mov_b32 v156, v132
    v_mov_b32 v157, v133
    s_nop 1
    v_permlane16_swap_b32 v156, v132
    v_permlane16_swap_b32 v157, v133
    s_nop 0
    v_add_f32 v132, v132, v156
    v_add_f32 v133, v133, v157
    v_mov_b32 v156, v132
    v_mov_b32 v157, v133
    s_nop 1
    v_permlane32_swap_b32 v156, v132
    v_permlane32_swap_b32 v157, v133
    s_nop 0
    v_add_f32 v132, v132, v156
    v_add_f32 v133, v133, v157
    v_mul_f32 v136, 0x3b000000, v132
    v_mul_f32 v140, 0x3b000000, v133
    v_sub_f32 v116, v116, v136
    v_sub_f32 v124, v124, v140
    v_sub_f32 v117, v117, v136
    v_sub_f32 v125, v125, v140
    v_sub_f32 v118, v118, v136
    v_sub_f32 v126, v126, v140
    v_sub_f32 v119, v119, v136
    v_sub_f32 v127, v127, v140
    v_sub_f32 v120, v120, v136
    v_sub_f32 v128, v128, v140
    v_sub_f32 v121, v121, v136
    v_sub_f32 v129, v129, v140
    v_sub_f32 v122, v122, v136
    v_sub_f32 v130, v130, v140
    v_sub_f32 v123, v123, v136
    v_sub_f32 v131, v131, v140
    v_mul_f32 v132, v116, v116
    v_mul_f32 v133, v124, v124
    v_fmac_f32 v132, v117, v117
    v_fmac_f32 v133, v125, v125
    v_fmac_f32 v132, v118, v118
    v_fmac_f32 v133, v126, v126
    v_fmac_f32 v132, v119, v119
    v_fmac_f32 v133, v127, v127
    v_fmac_f32 v132, v120, v120
    v_fmac_f32 v133, v128, v128
    v_fmac_f32 v132, v121, v121
    v_fmac_f32 v133, v129, v129
    v_fmac_f32 v132, v122, v122
    v_fmac_f32 v133, v130, v130
    v_fmac_f32 v132, v123, v123
    v_fmac_f32 v133, v131, v131
    s_nop 0
    v_add_f32_dpp v132, v132, v132 quad_perm:[1,0,3,2] row_mask:0xf bank_mask:0xf
    v_add_f32_dpp v133, v133, v133 quad_perm:[1,0,3,2] row_mask:0xf bank_mask:0xf
    s_nop 0
    v_add_f32_dpp v132, v132, v132 quad_perm:[2,3,0,1] row_mask:0xf bank_mask:0xf
    v_add_f32_dpp v133, v133, v133 quad_perm:[2,3,0,1] row_mask:0xf bank_mask:0xf
    s_nop 0
    v_add_f32_dpp v132, v132, v132 row_half_mirror row_mask:0xf bank_mask:0xf
    v_add_f32_dpp v133, v133, v133 row_half_mirror row_mask:0xf bank_mask:0xf
    s_nop 0
    v_add_f32_dpp v132, v132, v132 row_mirror row_mask:0xf bank_mask:0xf
    v_add_f32_dpp v133, v133, v133 row_mirror row_mask:0xf bank_mask:0xf
    v_mov_b32 v156, v132
    v_mov_b32 v157, v133
    s_nop 1
    v_permlane16_swap_b32 v156, v132
    v_permlane16_swap_b32 v157, v133
    s_nop 0
    v_add_f32 v132, v132, v156
    v_add_f32 v133, v133, v157
    v_mov_b32 v156, v132
    v_mov_b32 v157, v133
    s_nop 1
    v_permlane32_swap_b32 v156, v132
    v_permlane32_swap_b32 v157, v133
    s_nop 0
    v_add_f32 v132, v132, v156
    v_add_f32 v133, v133, v157
    v_mov_b32 v116, 0x3727c5ac
    v_mov_b32 v117, 0x3727c5ac
    v_fmac_f32 v116, 0x3b000000, v132
    v_fmac_f32 v117, 0x3b000000, v133
    v_rsq_f32 v116, v116
    v_rsq_f32 v117, v117
    v_mov_b32 v138, 0
    v_mov_b32 v139, s61
    v_mov_b32 v142, 0
    v_mov_b32 v143, s61
    v_mul_f32 v137, 0x3fb8aa3b, v116
    v_mul_f32 v141, 0x3fb8aa3b, v117
    v_cmp_eq_u32 vcc, 0, v0
    v_mov_b32 v118, 1073741824
    s_nop 0
    v_cndmask_b32 v118, v118, 0, vcc
    buffer_store_dwordx4 v[136:139], v118, s[40:43], s84 offen sc1
    buffer_store_dwordx4 v[140:143], v118, s[40:43], s84 offen offset:16 sc1
    s_waitcnt vmcnt(2)
    v_lshlrev_b32 v119, 16, v172
    v_mul_f32 v119, 0x3fb8aa3b, v119
    v_lshlrev_b32 v120, 2, v173
    v_add_u32 v120, 160512, v120
    s_cmp_eq_u32 s52, 3
    s_cbranch_scc1 L_nobt
    ds_write_b32 v120, v119
L_nobt:
    v_cmp_eq_u32 vcc, 0, v0
    v_mov_b32 v240, 1073741824
    s_nop 0
    v_cndmask_b32 v240, v240, 0, vcc
    v_mov_b32 v241, s61
    s_setprio 1
    s_cmp_lt_u32 s56, 8
    s_cbranch_scc1 L_Catt
    s_waitcnt lgkmcnt(0)
    s_barrier
    ds_read_b128 v[116:119], v2 offset:0
    ds_read_b64_tr_b16 v[132:133], v4 offset:0
    ds_read_b64_tr_b16 v[134:135], v4 offset:512
    ds_read_b128 v[120:123], v2 offset:2048
    ds_read_b128 v[124:127], v2 offset:4096
    ds_read_b128 v[128:131], v2 offset:6144
    ds_read_b64_tr_b16 v[136:137], v5 offset:0
    ds_read_b64_tr_b16 v[138:139], v5 offset:512
    ds_read_b64_tr_b16 v[140:141], v4 offset:1024
    ds_read_b64_tr_b16 v[142:143], v4 offset:1536
    ds_read_b64_tr_b16 v[144:145], v5 offset:1024
    ds_read_b64_tr_b16 v[146:147], v5 offset:1536
    ds_read_b64_tr_b16 v[148:149], v4 offset:2048
    ds_read_b64_tr_b16 v[150:151], v4 offset:2560
    ds_read_b64_tr_b16 v[152:153], v5 offset:2048
    ds_read_b64_tr_b16 v[154:155], v5 offset:2560
    s_waitcnt lgkmcnt(13)
    v_mfma_f32_16x16x32_bf16 v[20:23], v[132:135], v[116:119], 0
    ds_read_b128 v[156:159], v3 offset:0
    s_waitcnt lgkmcnt(11)
    v_mfma_f32_16x16x32_bf16 v[28:31], v[132:135], v[120:123], 0
    ds_read_b64_tr_b16 v[172:173], v4 offset:12288
    v_mfma_f32_16x16x32_bf16 v[36:39], v[132:135], v[124:127], 0
    ds_read_b64_tr_b16 v[174:175], v4 offset:12800
    v_mfma_f32_16x16x32_bf16 v[44:47], v[132:135], v[128:131], 0
    ds_read_b128 v[160:163], v3 offset:2048
    s_waitcnt lgkmcnt(12)
    v_mfma_f32_16x16x32_bf16 v[48:51], v[136:139], v[128:131], 0
    ds_read_b128 v[164:167], v3 offset:4096
    v_mfma_f32_16x16x32_bf16 v[40:43], v[136:139], v[124:127], 0
    ds_read_b128 v[168:171], v3 offset:6144
    v_mfma_f32_16x16x32_bf16 v[32:35], v[136:139], v[120:123], 0
    ds_read_b64_tr_b16 v[176:177], v5 offset:12288
    v_mfma_f32_16x16x32_bf16 v[24:27], v[136:139], v[116:119], 0
    ds_read_b64_tr_b16 v[178:179], v5 offset:12800
    s_waitcnt lgkmcnt(14)
    v_mfma_f32_16x16x32_bf16 v[52:55], v[140:143], v[116:119], 0
    ds_read_b64_tr_b16 v[180:181], v4 offset:13312
    v_mfma_f32_16x16x32_bf16 v[60:63], v[140:143], v[120:123], 0
    ds_read_b64_tr_b16 v[182:183], v4 offset:13824
    v_mfma_f32_16x16x32_bf16 v[68:71], v[140:143], v[124:127], 0
    ds_read_b64_tr_b16 v[184:185], v5 offset:13312
    v_mfma_f32_16x16x32_bf16 v[76:79], v[140:143], v[128:131], 0
    ds_read_b64_tr_b16 v[186:187], v5 offset:13824
    s_waitcnt lgkmcnt(15)
    v_mfma_f32_16x16x32_bf16 v[80:83], v[144:147], v[128:131], 0
    ds_read_b64_tr_b16 v[188:189], v4 offset:14336
    v_mfma_f32_16x16x32_bf16 v[72:75], v[144:147], v[124:127], 0
    ds_read_b64_tr_b16 v[190:191], v4 offset:14848
    v_mfma_f32_16x16x32_bf16 v[64:67], v[144:147], v[120:123], 0
    ds_read_b64_tr_b16 v[192:193], v5 offset:14336
    v_mfma_f32_16x16x32_bf16 v[56:59], v[144:147], v[116:119], 0
    ds_read_b64_tr_b16 v[194:195], v5 offset:14848
    s_waitcnt lgkmcnt(15)
    v_mfma_f32_16x16x32_bf16 v[84:87], v[148:151], v[116:119], 0
    v_mfma_f32_16x16x32_bf16 v[92:95], v[148:151], v[120:123], 0
    v_mfma_f32_16x16x32_bf16 v[100:103], v[148:151], v[124:127], 0
    v_mfma_f32_16x16x32_bf16 v[108:111], v[148:151], v[128:131], 0
    s_waitcnt lgkmcnt(15)
    v_mfma_f32_16x16x32_bf16 v[112:115], v[152:155], v[128:131], 0
    v_mfma_f32_16x16x32_bf16 v[104:107], v[152:155], v[124:127], 0
    v_mfma_f32_16x16x32_bf16 v[96:99], v[152:155], v[120:123], 0
    v_mfma_f32_16x16x32_bf16 v[88:91], v[152:155], v[116:119], 0
    s_waitcnt lgkmcnt(0)
    s_barrier
    v_mfma_f32_16x16x32_bf16 v[20:23], v[172:175], v[156:159], v[20:23]
    ds_read_b128 v[116:119], v2 offset:16384
    v_mfma_f32_16x16x32_bf16 v[28:31], v[172:175], v[160:163], v[28:31]
    ds_read_b64_tr_b16 v[132:133], v4 offset:24576
    v_mfma_f32_16x16x32_bf16 v[36:39], v[172:175], v[164:167], v[36:39]
    ds_read_b64_tr_b16 v[134:135], v4 offset:25088
    v_mfma_f32_16x16x32_bf16 v[44:47], v[172:175], v[168:171], v[44:47]
    ds_read_b128 v[120:123], v2 offset:18432
    v_mfma_f32_16x16x32_bf16 v[48:51], v[176:179], v[168:171], v[48:51]
    ds_read_b128 v[124:127], v2 offset:20480
    v_mfma_f32_16x16x32_bf16 v[40:43], v[176:179], v[164:167], v[40:43]
    ds_read_b128 v[128:131], v2 offset:22528
    v_mfma_f32_16x16x32_bf16 v[32:35], v[176:179], v[160:163], v[32:35]
    ds_read_b64_tr_b16 v[136:137], v5 offset:24576
    v_mfma_f32_16x16x32_bf16 v[24:27], v[176:179], v[156:159], v[24:27]
    ds_read_b64_tr_b16 v[138:139], v5 offset:25088
    v_mfma_f32_16x16x32_bf16 v[52:55], v[180:183], v[156:159], v[52:55]
    ds_read_b64_tr_b16 v[140:141], v4 offset:25600
    v_mfma_f32_16x16x32_bf16 v[60:63], v[180:183], v[160:163], v[60:63]
    ds_read_b64_tr_b16 v[142:143], v4 offset:26112
    v_mfma_f32_16x16x32_bf16 v[68:71], v[180:183], v[164:167], v[68:71]
    ds_read_b64_tr_b16 v[144:145], v5 offset:25600
    v_mfma_f32_16x16x32_bf16 v[76:79], v[180:183], v[168:171], v[76:79]
    ds_read_b64_tr_b16 v[146:147], v5 offset:26112
    v_mfma_f32_16x16x32_bf16 v[80:83], v[184:187], v[168:171], v[80:83]
    ds_read_b64_tr_b16 v[148:149], v4 offset:26624
    v_mfma_f32_16x16x32_bf16 v[72:75], v[184:187], v[164:167], v[72:75]
    ds_read_b64_tr_b16 v[150:151], v4 offset:27136
    v_mfma_f32_16x16x32_bf16 v[64:67], v[184:187], v[160:163], v[64:67]
    ds_read_b64_tr_b16 v[152:153], v5 offset:26624
    v_mfma_f32_16x16x32_bf16 v[56:59], v[184:187], v[156:159], v[56:59]
    ds_read_b64_tr_b16 v[154:155], v5 offset:27136
    v_mfma_f32_16x16x32_bf16 v[84:87], v[188:191], v[156:159], v[84:87]
    v_mfma_f32_16x16x32_bf16 v[92:95], v[188:191], v[160:163], v[92:95]
    v_mfma_f32_16x16x32_bf16 v[100:103], v[188:191], v[164:167], v[100:103]
    v_mfma_f32_16x16x32_bf16 v[108:111], v[188:191], v[168:171], v[108:111]
    v_mfma_f32_16x16x32_bf16 v[112:115], v[192:195], v[168:171], v[112:115]
    v_mfma_f32_16x16x32_bf16 v[104:107], v[192:195], v[164:167], v[104:107]
    v_mfma_f32_16x16x32_bf16 v[96:99], v[192:195], v[160:163], v[96:99]
    v_mfma_f32_16x16x32_bf16 v[88:91], v[192:195], v[156:159], v[88:91]
    s_waitcnt lgkmcnt(13)
    v_mfma_f32_16x16x32_bf16 v[20:23], v[132:135], v[116:119], v[20:23]
    ds_read_b128 v[156:159], v3 offset:16384
    s_waitcnt lgkmcnt(11)
    v_mfma_f32_16x16x32_bf16 v[28:31], v[132:135], v[120:123], v[28:31]
    ds_read_b64_tr_b16 v[172:173], v4 offset:36864
    v_mfma_f32_16x16x32_bf16 v[36:39], v[132:135], v[124:127], v[36:39]
    ds_read_b64_tr_b16 v[174:175], v4 offset:37376
    v_mfma_f32_16x16x32_bf16 v[44:47], v[132:135], v[128:131], v[44:47]
    ds_read_b128 v[160:163], v3 offset:18432
    s_waitcnt lgkmcnt(12)
    v_mfma_f32_16x16x32_bf16 v[48:51], v[136:139], v[128:131], v[48:51]
    ds_read_b128 v[164:167], v3 offset:20480
    v_mfma_f32_16x16x32_bf16 v[40:43], v[136:139], v[124:127], v[40:43]
    ds_read_b128 v[168:171], v3 offset:22528
    v_mfma_f32_16x16x32_bf16 v[32:35], v[136:139], v[120:123], v[32:35]
    ds_read_b64_tr_b16 v[176:177], v5 offset:36864
    v_mfma_f32_16x16x32_bf16 v[24:27], v[136:139], v[116:119], v[24:27]
    ds_read_b64_tr_b16 v[178:179], v5 offset:37376
    s_waitcnt lgkmcnt(14)
    v_mfma_f32_16x16x32_bf16 v[52:55], v[140:143], v[116:119], v[52:55]
    ds_read_b64_tr_b16 v[180:181], v4 offset:37888
    v_mfma_f32_16x16x32_bf16 v[60:63], v[140:143], v[120:123], v[60:63]
    ds_read_b64_tr_b16 v[182:183], v4 offset:38400
    v_mfma_f32_16x16x32_bf16 v[68:71], v[140:143], v[124:127], v[68:71]
    ds_read_b64_tr_b16 v[184:185], v5 offset:37888
    v_mfma_f32_16x16x32_bf16 v[76:79], v[140:143], v[128:131], v[76:79]
    ds_read_b64_tr_b16 v[186:187], v5 offset:38400
    s_waitcnt lgkmcnt(15)
    v_mfma_f32_16x16x32_bf16 v[80:83], v[144:147], v[128:131], v[80:83]
    ds_read_b64_tr_b16 v[188:189], v4 offset:38912
    v_mfma_f32_16x16x32_bf16 v[72:75], v[144:147], v[124:127], v[72:75]
    ds_read_b64_tr_b16 v[190:191], v4 offset:39424
    v_mfma_f32_16x16x32_bf16 v[64:67], v[144:147], v[120:123], v[64:67]
    ds_read_b64_tr_b16 v[192:193], v5 offset:38912
    v_mfma_f32_16x16x32_bf16 v[56:59], v[144:147], v[116:119], v[56:59]
    ds_read_b64_tr_b16 v[194:195], v5 offset:39424
    s_waitcnt lgkmcnt(15)
    v_mfma_f32_16x16x32_bf16 v[84:87], v[148:151], v[116:119], v[84:87]
    v_mfma_f32_16x16x32_bf16 v[92:95], v[148:151], v[120:123], v[92:95]
    v_mfma_f32_16x16x32_bf16 v[100:103], v[148:151], v[124:127], v[100:103]
    v_mfma_f32_16x16x32_bf16 v[108:111], v[148:151], v[128:131], v[108:111]
    s_waitcnt lgkmcnt(15)
    v_mfma_f32_16x16x32_bf16 v[112:115], v[152:155], v[128:131], v[112:115]
    v_mfma_f32_16x16x32_bf16 v[104:107], v[152:155], v[124:127], v[104:107]
    v_mfma_f32_16x16x32_bf16 v[96:99], v[152:155], v[120:123], v[96:99]
    v_mfma_f32_16x16x32_bf16 v[88:91], v[152:155], v[116:119], v[88:91]
    s_waitcnt lgkmcnt(0)
    s_barrier
    v_mfma_f32_16x16x32_bf16 v[20:23], v[172:175], v[156:159], v[20:23]
    ds_read_b128 v[116:119], v2 offset:32768
    v_mfma_f32_16x16x32_bf16 v[28:31], v[172:175], v[160:163], v[28:31]
    ds_read_b64_tr_b16 v[132:133], v4 offset:49152
    v_mfma_f32_16x16x32_bf16 v[36:39], v[172:175], v[164:167], v[36:39]
    ds_read_b64_tr_b16 v[134:135], v4 offset:49664
    v_mfma_f32_16x16x32_bf16 v[44:47], v[172:175], v[168:171], v[44:47]
    ds_read_b128 v[120:123], v2 offset:34816
    v_mfma_f32_16x16x32_bf16 v[48:51], v[176:179], v[168:171], v[48:51]
    ds_read_b128 v[124:127], v2 offset:36864
    v_mfma_f32_16x16x32_bf16 v[40:43], v[176:179], v[164:167], v[40:43]
    ds_read_b128 v[128:131], v2 offset:38912
    v_mfma_f32_16x16x32_bf16 v[32:35], v[176:179], v[160:163], v[32:35]
    ds_read_b64_tr_b16 v[136:137], v5 offset:49152
    v_mfma_f32_16x16x32_bf16 v[24:27], v[176:179], v[156:159], v[24:27]
    ds_read_b64_tr_b16 v[138:139], v5 offset:49664
    v_mfma_f32_16x16x32_bf16 v[52:55], v[180:183], v[156:159], v[52:55]
    ds_read_b64_tr_b16 v[140:141], v4 offset:50176
    v_mfma_f32_16x16x32_bf16 v[60:63], v[180:183], v[160:163], v[60:63]
    ds_read_b64_tr_b16 v[142:143], v4 offset:50688
    v_mfma_f32_16x16x32_bf16 v[68:71], v[180:183], v[164:167], v[68:71]
    ds_read_b64_tr_b16 v[144:145], v5 offset:50176
    v_mfma_f32_16x16x32_bf16 v[76:79], v[180:183], v[168:171], v[76:79]
    ds_read_b64_tr_b16 v[146:147], v5 offset:50688
    v_mfma_f32_16x16x32_bf16 v[80:83], v[184:187], v[168:171], v[80:83]
    ds_read_b64_tr_b16 v[148:149], v4 offset:51200
    v_mfma_f32_16x16x32_bf16 v[72:75], v[184:187], v[164:167], v[72:75]
    ds_read_b64_tr_b16 v[150:151], v4 offset:51712
    v_mfma_f32_16x16x32_bf16 v[64:67], v[184:187], v[160:163], v[64:67]
    ds_read_b64_tr_b16 v[152:153], v5 offset:51200
    v_mfma_f32_16x16x32_bf16 v[56:59], v[184:187], v[156:159], v[56:59]
    ds_read_b64_tr_b16 v[154:155], v5 offset:51712
    v_mfma_f32_16x16x32_bf16 v[84:87], v[188:191], v[156:159], v[84:87]
    v_mfma_f32_16x16x32_bf16 v[92:95], v[188:191], v[160:163], v[92:95]
    v_mfma_f32_16x16x32_bf16 v[100:103], v[188:191], v[164:167], v[100:103]
    v_mfma_f32_16x16x32_bf16 v[108:111], v[188:191], v[168:171], v[108:111]
    v_mfma_f32_16x16x32_bf16 v[112:115], v[192:195], v[168:171], v[112:115]
    v_mfma_f32_16x16x32_bf16 v[104:107], v[192:195], v[164:167], v[104:107]
    v_mfma_f32_16x16x32_bf16 v[96:99], v[192:195], v[160:163], v[96:99]
    v_mfma_f32_16x16x32_bf16 v[88:91], v[192:195], v[156:159], v[88:91]
    s_waitcnt lgkmcnt(13)
    v_mfma_f32_16x16x32_bf16 v[20:23], v[132:135], v[116:119], v[20:23]
    ds_read_b128 v[156:159], v3 offset:32768
    s_waitcnt lgkmcnt(11)
    v_mfma_f32_16x16x32_bf16 v[28:31], v[132:135], v[120:123], v[28:31]
    ds_read_b64_tr_b16 v[172:173], v4 offset:61440
    v_mfma_f32_16x16x32_bf16 v[36:39], v[132:135], v[124:127], v[36:39]
    ds_read_b64_tr_b16 v[174:175], v4 offset:61952
    v_mfma_f32_16x16x32_bf16 v[44:47], v[132:135], v[128:131], v[44:47]
    ds_read_b128 v[160:163], v3 offset:34816
    s_waitcnt lgkmcnt(12)
    v_mfma_f32_16x16x32_bf16 v[48:51], v[136:139], v[128:131], v[48:51]
    ds_read_b128 v[164:167], v3 offset:36864
    v_mfma_f32_16x16x32_bf16 v[40:43], v[136:139], v[124:127], v[40:43]
    ds_read_b128 v[168:171], v3 offset:38912
    v_mfma_f32_16x16x32_bf16 v[32:35], v[136:139], v[120:123], v[32:35]
    ds_read_b64_tr_b16 v[176:177], v5 offset:61440
    v_mfma_f32_16x16x32_bf16 v[24:27], v[136:139], v[116:119], v[24:27]
    ds_read_b64_tr_b16 v[178:179], v5 offset:61952
    s_waitcnt lgkmcnt(14)
    v_mfma_f32_16x16x32_bf16 v[52:55], v[140:143], v[116:119], v[52:55]
    ds_read_b64_tr_b16 v[180:181], v4 offset:62464
    v_mfma_f32_16x16x32_bf16 v[60:63], v[140:143], v[120:123], v[60:63]
    ds_read_b64_tr_b16 v[182:183], v4 offset:62976
    v_mfma_f32_16x16x32_bf16 v[68:71], v[140:143], v[124:127], v[68:71]
    ds_read_b64_tr_b16 v[184:185], v5 offset:62464
    v_mfma_f32_16x16x32_bf16 v[76:79], v[140:143], v[128:131], v[76:79]
    ds_read_b64_tr_b16 v[186:187], v5 offset:62976
    s_waitcnt lgkmcnt(15)
    v_mfma_f32_16x16x32_bf16 v[80:83], v[144:147], v[128:131], v[80:83]
    ds_read_b64_tr_b16 v[188:189], v4 offset:63488
    v_mfma_f32_16x16x32_bf16 v[72:75], v[144:147], v[124:127], v[72:75]
    ds_read_b64_tr_b16 v[190:191], v4 offset:64000
    v_mfma_f32_16x16x32_bf16 v[64:67], v[144:147], v[120:123], v[64:67]
    ds_read_b64_tr_b16 v[192:193], v5 offset:63488
    v_mfma_f32_16x16x32_bf16 v[56:59], v[144:147], v[116:119], v[56:59]
    ds_read_b64_tr_b16 v[194:195], v5 offset:64000
    s_waitcnt lgkmcnt(15)
    v_mfma_f32_16x16x32_bf16 v[84:87], v[148:151], v[116:119], v[84:87]
    v_mfma_f32_16x16x32_bf16 v[92:95], v[148:151], v[120:123], v[92:95]
    v_mfma_f32_16x16x32_bf16 v[100:103], v[148:151], v[124:127], v[100:103]
    v_mfma_f32_16x16x32_bf16 v[108:111], v[148:151], v[128:131], v[108:111]
    s_waitcnt lgkmcnt(15)
    v_mfma_f32_16x16x32_bf16 v[112:115], v[152:155], v[128:131], v[112:115]
    v_mfma_f32_16x16x32_bf16 v[104:107], v[152:155], v[124:127], v[104:107]
    v_mfma_f32_16x16x32_bf16 v[96:99], v[152:155], v[120:123], v[96:99]
    v_mfma_f32_16x16x32_bf16 v[88:91], v[152:155], v[116:119], v[88:91]
    s_waitcnt lgkmcnt(0)
    s_barrier
    v_mfma_f32_16x16x32_bf16 v[20:23], v[172:175], v[156:159], v[20:23]
    ds_read_b128 v[116:119], v2 offset:0
    v_mfma_f32_16x16x32_bf16 v[28:31], v[172:175], v[160:163], v[28:31]
    ds_read_b64_tr_b16 v[132:133], v4 offset:0
    v_mfma_f32_16x16x32_bf16 v[36:39], v[172:175], v[164:167], v[36:39]
    ds_read_b64_tr_b16 v[134:135], v4 offset:512
    v_mfma_f32_16x16x32_bf16 v[44:47], v[172:175], v[168:171], v[44:47]
    ds_read_b128 v[120:123], v2 offset:2048
    v_mfma_f32_16x16x32_bf16 v[48:51], v[176:179], v[168:171], v[48:51]
    ds_read_b128 v[124:127], v2 offset:4096
    v_mfma_f32_16x16x32_bf16 v[40:43], v[176:179], v[164:167], v[40:43]
    ds_read_b128 v[128:131], v2 offset:6144
    v_mfma_f32_16x16x32_bf16 v[32:35], v[176:179], v[160:163], v[32:35]
    ds_read_b64_tr_b16 v[136:137], v5 offset:0
    v_mfma_f32_16x16x32_bf16 v[24:27], v[176:179], v[156:159], v[24:27]
    ds_read_b64_tr_b16 v[138:139], v5 offset:512
    v_mfma_f32_16x16x32_bf16 v[52:55], v[180:183], v[156:159], v[52:55]
    ds_read_b64_tr_b16 v[140:141], v4 offset:1024
    v_mfma_f32_16x16x32_bf16 v[60:63], v[180:183], v[160:163], v[60:63]
    ds_read_b64_tr_b16 v[142:143], v4 offset:1536
    v_mfma_f32_16x16x32_bf16 v[68:71], v[180:183], v[164:167], v[68:71]
    ds_read_b64_tr_b16 v[144:145], v5 offset:1024
    v_mfma_f32_16x16x32_bf16 v[76:79], v[180:183], v[168:171], v[76:79]
    ds_read_b64_tr_b16 v[146:147], v5 offset:1536
    v_mfma_f32_16x16x32_bf16 v[80:83], v[184:187], v[168:171], v[80:83]
    ds_read_b64_tr_b16 v[148:149], v4 offset:2048
    v_mfma_f32_16x16x32_bf16 v[72:75], v[184:187], v[164:167], v[72:75]
    ds_read_b64_tr_b16 v[150:151], v4 offset:2560
    v_mfma_f32_16x16x32_bf16 v[64:67], v[184:187], v[160:163], v[64:67]
    ds_read_b64_tr_b16 v[152:153], v5 offset:2048
    v_mfma_f32_16x16x32_bf16 v[56:59], v[184:187], v[156:159], v[56:59]
    ds_read_b64_tr_b16 v[154:155], v5 offset:2560
    v_mfma_f32_16x16x32_bf16 v[84:87], v[188:191], v[156:159], v[84:87]
    v_mfma_f32_16x16x32_bf16 v[92:95], v[188:191], v[160:163], v[92:95]
    v_mfma_f32_16x16x32_bf16 v[100:103], v[188:191], v[164:167], v[100:103]
    v_mfma_f32_16x16x32_bf16 v[108:111], v[188:191], v[168:171], v[108:111]
    v_mfma_f32_16x16x32_bf16 v[112:115], v[192:195], v[168:171], v[112:115]
    v_mfma_f32_16x16x32_bf16 v[104:107], v[192:195], v[164:167], v[104:107]
    v_mfma_f32_16x16x32_bf16 v[96:99], v[192:195], v[160:163], v[96:99]
    v_mfma_f32_16x16x32_bf16 v[88:91], v[192:195], v[156:159], v[88:91]
    s_waitcnt lgkmcnt(13)
    v_mfma_f32_16x16x32_bf16 v[20:23], v[132:135], v[116:119], v[20:23]
    ds_read_b128 v[156:159], v3 offset:0
    s_waitcnt lgkmcnt(11)
    v_mfma_f32_16x16x32_bf16 v[28:31], v[132:135], v[120:123], v[28:31]
    ds_read_b64_tr_b16 v[172:173], v4 offset:12288
    v_mfma_f32_16x16x32_bf16 v[36:39], v[132:135], v[124:127], v[36:39]
    ds_read_b64_tr_b16 v[174:175], v4 offset:12800
    v_mfma_f32_16x16x32_bf16 v[44:47], v[132:135], v[128:131], v[44:47]
    ds_read_b128 v[160:163], v3 offset:2048
    s_waitcnt lgkmcnt(12)
    v_mfma_f32_16x16x32_bf16 v[48:51], v[136:139], v[128:131], v[48:51]
    ds_read_b128 v[164:167], v3 offset:4096
    v_mfma_f32_16x16x32_bf16 v[40:43], v[136:139], v[124:127], v[40:43]
    ds_read_b128 v[168:171], v3 offset:6144
    v_mfma_f32_16x16x32_bf16 v[32:35], v[136:139], v[120:123], v[32:35]
    ds_read_b64_tr_b16 v[176:177], v5 offset:12288
    v_mfma_f32_16x16x32_bf16 v[24:27], v[136:139], v[116:119], v[24:27]
    ds_read_b64_tr_b16 v[178:179], v5 offset:12800
    s_waitcnt lgkmcnt(14)
    v_mfma_f32_16x16x32_bf16 v[52:55], v[140:143], v[116:119], v[52:55]
    ds_read_b64_tr_b16 v[180:181], v4 offset:13312
    v_mfma_f32_16x16x32_bf16 v[60:63], v[140:143], v[120:123], v[60:63]
    ds_read_b64_tr_b16 v[182:183], v4 offset:13824
    v_mfma_f32_16x16x32_bf16 v[68:71], v[140:143], v[124:127], v[68:71]
    ds_read_b64_tr_b16 v[184:185], v5 offset:13312
    v_mfma_f32_16x16x32_bf16 v[76:79], v[140:143], v[128:131], v[76:79]
    ds_read_b64_tr_b16 v[186:187], v5 offset:13824
    s_waitcnt lgkmcnt(15)
    v_mfma_f32_16x16x32_bf16 v[80:83], v[144:147], v[128:131], v[80:83]
    ds_read_b64_tr_b16 v[188:189], v4 offset:14336
    v_mfma_f32_16x16x32_bf16 v[72:75], v[144:147], v[124:127], v[72:75]
    ds_read_b64_tr_b16 v[190:191], v4 offset:14848
    v_mfma_f32_16x16x32_bf16 v[64:67], v[144:147], v[120:123], v[64:67]
    ds_read_b64_tr_b16 v[192:193], v5 offset:14336
    v_mfma_f32_16x16x32_bf16 v[56:59], v[144:147], v[116:119], v[56:59]
    ds_read_b64_tr_b16 v[194:195], v5 offset:14848
    s_waitcnt lgkmcnt(15)
    v_mfma_f32_16x16x32_bf16 v[84:87], v[148:151], v[116:119], v[84:87]
    v_mfma_f32_16x16x32_bf16 v[92:95], v[148:151], v[120:123], v[92:95]
    v_mfma_f32_16x16x32_bf16 v[100:103], v[148:151], v[124:127], v[100:103]
    v_mfma_f32_16x16x32_bf16 v[108:111], v[148:151], v[128:131], v[108:111]
    s_waitcnt lgkmcnt(15)
    v_mfma_f32_16x16x32_bf16 v[112:115], v[152:155], v[128:131], v[112:115]
    v_mfma_f32_16x16x32_bf16 v[104:107], v[152:155], v[124:127], v[104:107]
    v_mfma_f32_16x16x32_bf16 v[96:99], v[152:155], v[120:123], v[96:99]
    v_mfma_f32_16x16x32_bf16 v[88:91], v[152:155], v[116:119], v[88:91]
    s_waitcnt lgkmcnt(0)
    s_barrier
    v_mfma_f32_16x16x32_bf16 v[20:23], v[172:175], v[156:159], v[20:23]
    ds_read_b128 v[116:119], v2 offset:16384
    v_mfma_f32_16x16x32_bf16 v[28:31], v[172:175], v[160:163], v[28:31]
    ds_read_b64_tr_b16 v[132:133], v4 offset:24576
    v_mfma_f32_16x16x32_bf16 v[36:39], v[172:175], v[164:167], v[36:39]
    ds_read_b64_tr_b16 v[134:135], v4 offset:25088
    v_mfma_f32_16x16x32_bf16 v[44:47], v[172:175], v[168:171], v[44:47]
    ds_read_b128 v[120:123], v2 offset:18432
    v_mfma_f32_16x16x32_bf16 v[48:51], v[176:179], v[168:171], v[48:51]
    ds_read_b128 v[124:127], v2 offset:20480
    v_mfma_f32_16x16x32_bf16 v[40:43], v[176:179], v[164:167], v[40:43]
    ds_read_b128 v[128:131], v2 offset:22528
    v_mfma_f32_16x16x32_bf16 v[32:35], v[176:179], v[160:163], v[32:35]
    ds_read_b64_tr_b16 v[136:137], v5 offset:24576
    v_mfma_f32_16x16x32_bf16 v[24:27], v[176:179], v[156:159], v[24:27]
    ds_read_b64_tr_b16 v[138:139], v5 offset:25088
    v_mfma_f32_16x16x32_bf16 v[52:55], v[180:183], v[156:159], v[52:55]
    ds_read_b64_tr_b16 v[140:141], v4 offset:25600
    v_mfma_f32_16x16x32_bf16 v[60:63], v[180:183], v[160:163], v[60:63]
    ds_read_b64_tr_b16 v[142:143], v4 offset:26112
    v_mfma_f32_16x16x32_bf16 v[68:71], v[180:183], v[164:167], v[68:71]
    ds_read_b64_tr_b16 v[144:145], v5 offset:25600
    v_mfma_f32_16x16x32_bf16 v[76:79], v[180:183], v[168:171], v[76:79]
    ds_read_b64_tr_b16 v[146:147], v5 offset:26112
    v_mfma_f32_16x16x32_bf16 v[80:83], v[184:187], v[168:171], v[80:83]
    ds_read_b64_tr_b16 v[148:149], v4 offset:26624
    v_mfma_f32_16x16x32_bf16 v[72:75], v[184:187], v[164:167], v[72:75]
    ds_read_b64_tr_b16 v[150:151], v4 offset:27136
    v_mfma_f32_16x16x32_bf16 v[64:67], v[184:187], v[160:163], v[64:67]
    ds_read_b64_tr_b16 v[152:153], v5 offset:26624
    v_mfma_f32_16x16x32_bf16 v[56:59], v[184:187], v[156:159], v[56:59]
    ds_read_b64_tr_b16 v[154:155], v5 offset:27136
    v_mfma_f32_16x16x32_bf16 v[84:87], v[188:191], v[156:159], v[84:87]
    v_mfma_f32_16x16x32_bf16 v[92:95], v[188:191], v[160:163], v[92:95]
    v_mfma_f32_16x16x32_bf16 v[100:103], v[188:191], v[164:167], v[100:103]
    v_mfma_f32_16x16x32_bf16 v[108:111], v[188:191], v[168:171], v[108:111]
    v_mfma_f32_16x16x32_bf16 v[112:115], v[192:195], v[168:171], v[112:115]
    v_mfma_f32_16x16x32_bf16 v[104:107], v[192:195], v[164:167], v[104:107]
    v_mfma_f32_16x16x32_bf16 v[96:99], v[192:195], v[160:163], v[96:99]
    v_mfma_f32_16x16x32_bf16 v[88:91], v[192:195], v[156:159], v[88:91]
    s_waitcnt lgkmcnt(13)
    v_mfma_f32_16x16x32_bf16 v[20:23], v[132:135], v[116:119], v[20:23]
    ds_read_b128 v[156:159], v3 offset:16384
    s_waitcnt lgkmcnt(11)
    v_mfma_f32_16x16x32_bf16 v[28:31], v[132:135], v[120:123], v[28:31]
    ds_read_b64_tr_b16 v[172:173], v4 offset:36864
    v_mfma_f32_16x16x32_bf16 v[36:39], v[132:135], v[124:127], v[36:39]
    ds_read_b64_tr_b16 v[174:175], v4 offset:37376
    v_mfma_f32_16x16x32_bf16 v[44:47], v[132:135], v[128:131], v[44:47]
    ds_read_b128 v[160:163], v3 offset:18432
    s_waitcnt lgkmcnt(12)
    v_mfma_f32_16x16x32_bf16 v[48:51], v[136:139], v[128:131], v[48:51]
    ds_read_b128 v[164:167], v3 offset:20480
    v_mfma_f32_16x16x32_bf16 v[40:43], v[136:139], v[124:127], v[40:43]
    ds_read_b128 v[168:171], v3 offset:22528
    v_mfma_f32_16x16x32_bf16 v[32:35], v[136:139], v[120:123], v[32:35]
    ds_read_b64_tr_b16 v[176:177], v5 offset:36864
    v_mfma_f32_16x16x32_bf16 v[24:27], v[136:139], v[116:119], v[24:27]
    ds_read_b64_tr_b16 v[178:179], v5 offset:37376
    s_waitcnt lgkmcnt(14)
    v_mfma_f32_16x16x32_bf16 v[52:55], v[140:143], v[116:119], v[52:55]
    ds_read_b64_tr_b16 v[180:181], v4 offset:37888
    v_mfma_f32_16x16x32_bf16 v[60:63], v[140:143], v[120:123], v[60:63]
    ds_read_b64_tr_b16 v[182:183], v4 offset:38400
    v_mfma_f32_16x16x32_bf16 v[68:71], v[140:143], v[124:127], v[68:71]
    ds_read_b64_tr_b16 v[184:185], v5 offset:37888
    v_mfma_f32_16x16x32_bf16 v[76:79], v[140:143], v[128:131], v[76:79]
    ds_read_b64_tr_b16 v[186:187], v5 offset:38400
    s_waitcnt lgkmcnt(15)
    v_mfma_f32_16x16x32_bf16 v[80:83], v[144:147], v[128:131], v[80:83]
    ds_read_b64_tr_b16 v[188:189], v4 offset:38912
    v_mfma_f32_16x16x32_bf16 v[72:75], v[144:147], v[124:127], v[72:75]
    ds_read_b64_tr_b16 v[190:191], v4 offset:39424
    v_mfma_f32_16x16x32_bf16 v[64:67], v[144:147], v[120:123], v[64:67]
    ds_read_b64_tr_b16 v[192:193], v5 offset:38912
    v_mfma_f32_16x16x32_bf16 v[56:59], v[144:147], v[116:119], v[56:59]
    ds_read_b64_tr_b16 v[194:195], v5 offset:39424
    s_waitcnt lgkmcnt(15)
    v_mfma_f32_16x16x32_bf16 v[84:87], v[148:151], v[116:119], v[84:87]
    v_mfma_f32_16x16x32_bf16 v[92:95], v[148:151], v[120:123], v[92:95]
    v_mfma_f32_16x16x32_bf16 v[100:103], v[148:151], v[124:127], v[100:103]
    v_mfma_f32_16x16x32_bf16 v[108:111], v[148:151], v[128:131], v[108:111]
    s_waitcnt lgkmcnt(15)
    v_mfma_f32_16x16x32_bf16 v[112:115], v[152:155], v[128:131], v[112:115]
    v_mfma_f32_16x16x32_bf16 v[104:107], v[152:155], v[124:127], v[104:107]
    v_mfma_f32_16x16x32_bf16 v[96:99], v[152:155], v[120:123], v[96:99]
    v_mfma_f32_16x16x32_bf16 v[88:91], v[152:155], v[116:119], v[88:91]
    s_waitcnt lgkmcnt(0)
    s_barrier
    v_mfma_f32_16x16x32_bf16 v[20:23], v[172:175], v[156:159], v[20:23]
    ds_read_b128 v[116:119], v2 offset:32768
    v_mfma_f32_16x16x32_bf16 v[28:31], v[172:175], v[160:163], v[28:31]
    ds_read_b64_tr_b16 v[132:133], v4 offset:49152
    v_mfma_f32_16x16x32_bf16 v[36:39], v[172:175], v[164:167], v[36:39]
    ds_read_b64_tr_b16 v[134:135], v4 offset:49664
    v_mfma_f32_16x16x32_bf16 v[44:47], v[172:175], v[168:171], v[44:47]
    ds_read_b128 v[120:123], v2 offset:34816
    v_mfma_f32_16x16x32_bf16 v[48:51], v[176:179], v[168:171], v[48:51]
    ds_read_b128 v[124:127], v2 offset:36864
    v_mfma_f32_16x16x32_bf16 v[40:43], v[176:179], v[164:167], v[40:43]
    ds_read_b128 v[128:131], v2 offset:38912
    v_mfma_f32_16x16x32_bf16 v[32:35], v[176:179], v[160:163], v[32:35]
    ds_read_b64_tr_b16 v[136:137], v5 offset:49152
    v_mfma_f32_16x16x32_bf16 v[24:27], v[176:179], v[156:159], v[24:27]
    ds_read_b64_tr_b16 v[138:139], v5 offset:49664
    v_mfma_f32_16x16x32_bf16 v[52:55], v[180:183], v[156:159], v[52:55]
    ds_read_b64_tr_b16 v[140:141], v4 offset:50176
    v_mfma_f32_16x16x32_bf16 v[60:63], v[180:183], v[160:163], v[60:63]
    ds_read_b64_tr_b16 v[142:143], v4 offset:50688
    v_mfma_f32_16x16x32_bf16 v[68:71], v[180:183], v[164:167], v[68:71]
    ds_read_b64_tr_b16 v[144:145], v5 offset:50176
    v_mfma_f32_16x16x32_bf16 v[76:79], v[180:183], v[168:171], v[76:79]
    ds_read_b64_tr_b16 v[146:147], v5 offset:50688
    v_mfma_f32_16x16x32_bf16 v[80:83], v[184:187], v[168:171], v[80:83]
    ds_read_b64_tr_b16 v[148:149], v4 offset:51200
    v_mfma_f32_16x16x32_bf16 v[72:75], v[184:187], v[164:167], v[72:75]
    ds_read_b64_tr_b16 v[150:151], v4 offset:51712
    v_mfma_f32_16x16x32_bf16 v[64:67], v[184:187], v[160:163], v[64:67]
    ds_read_b64_tr_b16 v[152:153], v5 offset:51200
    v_mfma_f32_16x16x32_bf16 v[56:59], v[184:187], v[156:159], v[56:59]
    ds_read_b64_tr_b16 v[154:155], v5 offset:51712
    v_mfma_f32_16x16x32_bf16 v[84:87], v[188:191], v[156:159], v[84:87]
    v_mfma_f32_16x16x32_bf16 v[92:95], v[188:191], v[160:163], v[92:95]
    v_mfma_f32_16x16x32_bf16 v[100:103], v[188:191], v[164:167], v[100:103]
    v_mfma_f32_16x16x32_bf16 v[108:111], v[188:191], v[168:171], v[108:111]
    v_mfma_f32_16x16x32_bf16 v[112:115], v[192:195], v[168:171], v[112:115]
    v_mfma_f32_16x16x32_bf16 v[104:107], v[192:195], v[164:167], v[104:107]
    v_mfma_f32_16x16x32_bf16 v[96:99], v[192:195], v[160:163], v[96:99]
    v_mfma_f32_16x16x32_bf16 v[88:91], v[192:195], v[156:159], v[88:91]
    s_waitcnt lgkmcnt(13)
    v_mfma_f32_16x16x32_bf16 v[20:23], v[132:135], v[116:119], v[20:23]
    ds_read_b128 v[156:159], v3 offset:32768
    s_waitcnt lgkmcnt(11)
    v_mfma_f32_16x16x32_bf16 v[28:31], v[132:135], v[120:123], v[28:31]
    ds_read_b64_tr_b16 v[172:173], v4 offset:61440
    v_mfma_f32_16x16x32_bf16 v[36:39], v[132:135], v[124:127], v[36:39]
    ds_read_b64_tr_b16 v[174:175], v4 offset:61952
    v_mfma_f32_16x16x32_bf16 v[44:47], v[132:135], v[128:131], v[44:47]
    ds_read_b128 v[160:163], v3 offset:34816
    s_waitcnt lgkmcnt(12)
    v_mfma_f32_16x16x32_bf16 v[48:51], v[136:139], v[128:131], v[48:51]
    ds_read_b128 v[164:167], v3 offset:36864
    v_mfma_f32_16x16x32_bf16 v[40:43], v[136:139], v[124:127], v[40:43]
    ds_read_b128 v[168:171], v3 offset:38912
    v_mfma_f32_16x16x32_bf16 v[32:35], v[136:139], v[120:123], v[32:35]
    ds_read_b64_tr_b16 v[176:177], v5 offset:61440
    v_mfma_f32_16x16x32_bf16 v[24:27], v[136:139], v[116:119], v[24:27]
    ds_read_b64_tr_b16 v[178:179], v5 offset:61952
    s_waitcnt lgkmcnt(14)
    v_mfma_f32_16x16x32_bf16 v[52:55], v[140:143], v[116:119], v[52:55]
    ds_read_b64_tr_b16 v[180:181], v4 offset:62464
    v_mfma_f32_16x16x32_bf16 v[60:63], v[140:143], v[120:123], v[60:63]
    ds_read_b64_tr_b16 v[182:183], v4 offset:62976
    v_mfma_f32_16x16x32_bf16 v[68:71], v[140:143], v[124:127], v[68:71]
    ds_read_b64_tr_b16 v[184:185], v5 offset:62464
    v_mfma_f32_16x16x32_bf16 v[76:79], v[140:143], v[128:131], v[76:79]
    ds_read_b64_tr_b16 v[186:187], v5 offset:62976
    s_waitcnt lgkmcnt(15)
    v_mfma_f32_16x16x32_bf16 v[80:83], v[144:147], v[128:131], v[80:83]
    ds_read_b64_tr_b16 v[188:189], v4 offset:63488
    v_mfma_f32_16x16x32_bf16 v[72:75], v[144:147], v[124:127], v[72:75]
    ds_read_b64_tr_b16 v[190:191], v4 offset:64000
    v_mfma_f32_16x16x32_bf16 v[64:67], v[144:147], v[120:123], v[64:67]
    ds_read_b64_tr_b16 v[192:193], v5 offset:63488
    v_mfma_f32_16x16x32_bf16 v[56:59], v[144:147], v[116:119], v[56:59]
    ds_read_b64_tr_b16 v[194:195], v5 offset:64000
    s_waitcnt lgkmcnt(15)
    v_mfma_f32_16x16x32_bf16 v[84:87], v[148:151], v[116:119], v[84:87]
    v_mfma_f32_16x16x32_bf16 v[92:95], v[148:151], v[120:123], v[92:95]
    v_mfma_f32_16x16x32_bf16 v[100:103], v[148:151], v[124:127], v[100:103]
    v_mfma_f32_16x16x32_bf16 v[108:111], v[148:151], v[128:131], v[108:111]
    s_waitcnt lgkmcnt(15)
    v_mfma_f32_16x16x32_bf16 v[112:115], v[152:155], v[128:131], v[112:115]
    v_mfma_f32_16x16x32_bf16 v[104:107], v[152:155], v[124:127], v[104:107]
    v_mfma_f32_16x16x32_bf16 v[96:99], v[152:155], v[120:123], v[96:99]
    v_mfma_f32_16x16x32_bf16 v[88:91], v[152:155], v[116:119], v[88:91]
    s_waitcnt lgkmcnt(0)
    s_barrier
    v_mfma_f32_16x16x32_bf16 v[20:23], v[172:175], v[156:159], v[20:23]
    ds_read_b128 v[116:119], v2 offset:0
    v_mfma_f32_16x16x32_bf16 v[28:31], v[172:175], v[160:163], v[28:31]
    ds_read_b64_tr_b16 v[132:133], v4 offset:0
    v_mfma_f32_16x16x32_bf16 v[36:39], v[172:175], v[164:167], v[36:39]
    ds_read_b64_tr_b16 v[134:135], v4 offset:512
    v_mfma_f32_16x16x32_bf16 v[44:47], v[172:175], v[168:171], v[44:47]
    ds_read_b128 v[120:123], v2 offset:2048
    v_mfma_f32_16x16x32_bf16 v[48:51], v[176:179], v[168:171], v[48:51]
    ds_read_b128 v[124:127], v2 offset:4096
    v_mfma_f32_16x16x32_bf16 v[40:43], v[176:179], v[164:167], v[40:43]
    ds_read_b128 v[128:131], v2 offset:6144
    v_mfma_f32_16x16x32_bf16 v[32:35], v[176:179], v[160:163], v[32:35]
    ds_read_b64_tr_b16 v[136:137], v5 offset:0
    v_mfma_f32_16x16x32_bf16 v[24:27], v[176:179], v[156:159], v[24:27]
    ds_read_b64_tr_b16 v[138:139], v5 offset:512
    v_mfma_f32_16x16x32_bf16 v[52:55], v[180:183], v[156:159], v[52:55]
    ds_read_b64_tr_b16 v[140:141], v4 offset:1024
    v_mfma_f32_16x16x32_bf16 v[60:63], v[180:183], v[160:163], v[60:63]
    ds_read_b64_tr_b16 v[142:143], v4 offset:1536
    v_mfma_f32_16x16x32_bf16 v[68:71], v[180:183], v[164:167], v[68:71]
    ds_read_b64_tr_b16 v[144:145], v5 offset:1024
    v_mfma_f32_16x16x32_bf16 v[76:79], v[180:183], v[168:171], v[76:79]
    ds_read_b64_tr_b16 v[146:147], v5 offset:1536
    v_mfma_f32_16x16x32_bf16 v[80:83], v[184:187], v[168:171], v[80:83]
    ds_read_b64_tr_b16 v[148:149], v4 offset:2048
    v_mfma_f32_16x16x32_bf16 v[72:75], v[184:187], v[164:167], v[72:75]
    ds_read_b64_tr_b16 v[150:151], v4 offset:2560
    v_mfma_f32_16x16x32_bf16 v[64:67], v[184:187], v[160:163], v[64:67]
    ds_read_b64_tr_b16 v[152:153], v5 offset:2048
    v_mfma_f32_16x16x32_bf16 v[56:59], v[184:187], v[156:159], v[56:59]
    ds_read_b64_tr_b16 v[154:155], v5 offset:2560
    v_mfma_f32_16x16x32_bf16 v[84:87], v[188:191], v[156:159], v[84:87]
    v_mfma_f32_16x16x32_bf16 v[92:95], v[188:191], v[160:163], v[92:95]
    v_mfma_f32_16x16x32_bf16 v[100:103], v[188:191], v[164:167], v[100:103]
    v_mfma_f32_16x16x32_bf16 v[108:111], v[188:191], v[168:171], v[108:111]
    v_mfma_f32_16x16x32_bf16 v[112:115], v[192:195], v[168:171], v[112:115]
    v_mfma_f32_16x16x32_bf16 v[104:107], v[192:195], v[164:167], v[104:107]
    v_mfma_f32_16x16x32_bf16 v[96:99], v[192:195], v[160:163], v[96:99]
    v_mfma_f32_16x16x32_bf16 v[88:91], v[192:195], v[156:159], v[88:91]
    s_waitcnt lgkmcnt(13)
    v_mfma_f32_16x16x32_bf16 v[20:23], v[132:135], v[116:119], v[20:23]
    ds_read_b128 v[156:159], v3 offset:0
    s_waitcnt lgkmcnt(11)
    v_mfma_f32_16x16x32_bf16 v[28:31], v[132:135], v[120:123], v[28:31]
    ds_read_b64_tr_b16 v[172:173], v4 offset:12288
    v_mfma_f32_16x16x32_bf16 v[36:39], v[132:135], v[124:127], v[36:39]
    ds_read_b64_tr_b16 v[174:175], v4 offset:12800
    v_mfma_f32_16x16x32_bf16 v[44:47], v[132:135], v[128:131], v[44:47]
    ds_read_b128 v[160:163], v3 offset:2048
    s_waitcnt lgkmcnt(12)
    v_mfma_f32_16x16x32_bf16 v[48:51], v[136:139], v[128:131], v[48:51]
    ds_read_b128 v[164:167], v3 offset:4096
    v_mfma_f32_16x16x32_bf16 v[40:43], v[136:139], v[124:127], v[40:43]
    ds_read_b128 v[168:171], v3 offset:6144
    v_mfma_f32_16x16x32_bf16 v[32:35], v[136:139], v[120:123], v[32:35]
    ds_read_b64_tr_b16 v[176:177], v5 offset:12288
    v_mfma_f32_16x16x32_bf16 v[24:27], v[136:139], v[116:119], v[24:27]
    ds_read_b64_tr_b16 v[178:179], v5 offset:12800
    s_waitcnt lgkmcnt(14)
    v_mfma_f32_16x16x32_bf16 v[52:55], v[140:143], v[116:119], v[52:55]
    ds_read_b64_tr_b16 v[180:181], v4 offset:13312
    v_mfma_f32_16x16x32_bf16 v[60:63], v[140:143], v[120:123], v[60:63]
    ds_read_b64_tr_b16 v[182:183], v4 offset:13824
    v_mfma_f32_16x16x32_bf16 v[68:71], v[140:143], v[124:127], v[68:71]
    ds_read_b64_tr_b16 v[184:185], v5 offset:13312
    v_mfma_f32_16x16x32_bf16 v[76:79], v[140:143], v[128:131], v[76:79]
    ds_read_b64_tr_b16 v[186:187], v5 offset:13824
    s_waitcnt lgkmcnt(15)
    v_mfma_f32_16x16x32_bf16 v[80:83], v[144:147], v[128:131], v[80:83]
    ds_read_b64_tr_b16 v[188:189], v4 offset:14336
    v_mfma_f32_16x16x32_bf16 v[72:75], v[144:147], v[124:127], v[72:75]
    ds_read_b64_tr_b16 v[190:191], v4 offset:14848
    v_mfma_f32_16x16x32_bf16 v[64:67], v[144:147], v[120:123], v[64:67]
    ds_read_b64_tr_b16 v[192:193], v5 offset:14336
    v_mfma_f32_16x16x32_bf16 v[56:59], v[144:147], v[116:119], v[56:59]
    ds_read_b64_tr_b16 v[194:195], v5 offset:14848
    s_waitcnt lgkmcnt(15)
    v_mfma_f32_16x16x32_bf16 v[84:87], v[148:151], v[116:119], v[84:87]
    v_mfma_f32_16x16x32_bf16 v[92:95], v[148:151], v[120:123], v[92:95]
    v_mfma_f32_16x16x32_bf16 v[100:103], v[148:151], v[124:127], v[100:103]
    v_mfma_f32_16x16x32_bf16 v[108:111], v[148:151], v[128:131], v[108:111]
    s_waitcnt lgkmcnt(15)
    v_mfma_f32_16x16x32_bf16 v[112:115], v[152:155], v[128:131], v[112:115]
    v_mfma_f32_16x16x32_bf16 v[104:107], v[152:155], v[124:127], v[104:107]
    v_mfma_f32_16x16x32_bf16 v[96:99], v[152:155], v[120:123], v[96:99]
    v_mfma_f32_16x16x32_bf16 v[88:91], v[152:155], v[116:119], v[88:91]
    s_waitcnt lgkmcnt(0)
    s_barrier
    v_mfma_f32_16x16x32_bf16 v[20:23], v[172:175], v[156:159], v[20:23]
    ds_read_b128 v[116:119], v2 offset:16384
    v_mfma_f32_16x16x32_bf16 v[28:31], v[172:175], v[160:163], v[28:31]
    ds_read_b64_tr_b16 v[132:133], v4 offset:24576
    v_mfma_f32_16x16x32_bf16 v[36:39], v[172:175], v[164:167], v[36:39]
    ds_read_b64_tr_b16 v[134:135], v4 offset:25088
    v_mfma_f32_16x16x32_bf16 v[44:47], v[172:175], v[168:171], v[44:47]
    ds_read_b128 v[120:123], v2 offset:18432
    v_mfma_f32_16x16x32_bf16 v[48:51], v[176:179], v[168:171], v[48:51]
    ds_read_b128 v[124:127], v2 offset:20480
    v_mfma_f32_16x16x32_bf16 v[40:43], v[176:179], v[164:167], v[40:43]
    ds_read_b128 v[128:131], v2 offset:22528
    v_mfma_f32_16x16x32_bf16 v[32:35], v[176:179], v[160:163], v[32:35]
    ds_read_b64_tr_b16 v[136:137], v5 offset:24576
    v_mfma_f32_16x16x32_bf16 v[24:27], v[176:179], v[156:159], v[24:27]
    ds_read_b64_tr_b16 v[138:139], v5 offset:25088
    v_mfma_f32_16x16x32_bf16 v[52:55], v[180:183], v[156:159], v[52:55]
    ds_read_b64_tr_b16 v[140:141], v4 offset:25600
    v_mfma_f32_16x16x32_bf16 v[60:63], v[180:183], v[160:163], v[60:63]
    ds_read_b64_tr_b16 v[142:143], v4 offset:26112
    v_mfma_f32_16x16x32_bf16 v[68:71], v[180:183], v[164:167], v[68:71]
    ds_read_b64_tr_b16 v[144:145], v5 offset:25600
    v_mfma_f32_16x16x32_bf16 v[76:79], v[180:183], v[168:171], v[76:79]
    ds_read_b64_tr_b16 v[146:147], v5 offset:26112
    v_mfma_f32_16x16x32_bf16 v[80:83], v[184:187], v[168:171], v[80:83]
    ds_read_b64_tr_b16 v[148:149], v4 offset:26624
    v_mfma_f32_16x16x32_bf16 v[72:75], v[184:187], v[164:167], v[72:75]
    ds_read_b64_tr_b16 v[150:151], v4 offset:27136
    v_mfma_f32_16x16x32_bf16 v[64:67], v[184:187], v[160:163], v[64:67]
    ds_read_b64_tr_b16 v[152:153], v5 offset:26624
    v_mfma_f32_16x16x32_bf16 v[56:59], v[184:187], v[156:159], v[56:59]
    ds_read_b64_tr_b16 v[154:155], v5 offset:27136
    v_mfma_f32_16x16x32_bf16 v[84:87], v[188:191], v[156:159], v[84:87]
    v_mfma_f32_16x16x32_bf16 v[92:95], v[188:191], v[160:163], v[92:95]
    v_mfma_f32_16x16x32_bf16 v[100:103], v[188:191], v[164:167], v[100:103]
    v_mfma_f32_16x16x32_bf16 v[108:111], v[188:191], v[168:171], v[108:111]
    v_mfma_f32_16x16x32_bf16 v[112:115], v[192:195], v[168:171], v[112:115]
    v_mfma_f32_16x16x32_bf16 v[104:107], v[192:195], v[164:167], v[104:107]
    v_mfma_f32_16x16x32_bf16 v[96:99], v[192:195], v[160:163], v[96:99]
    v_mfma_f32_16x16x32_bf16 v[88:91], v[192:195], v[156:159], v[88:91]
    s_waitcnt lgkmcnt(13)
    v_mfma_f32_16x16x32_bf16 v[20:23], v[132:135], v[116:119], v[20:23]
    ds_read_b128 v[156:159], v3 offset:16384
    s_waitcnt lgkmcnt(11)
    v_mfma_f32_16x16x32_bf16 v[28:31], v[132:135], v[120:123], v[28:31]
    ds_read_b64_tr_b16 v[172:173], v4 offset:36864
    v_mfma_f32_16x16x32_bf16 v[36:39], v[132:135], v[124:127], v[36:39]
    ds_read_b64_tr_b16 v[174:175], v4 offset:37376
    v_mfma_f32_16x16x32_bf16 v[44:47], v[132:135], v[128:131], v[44:47]
    ds_read_b128 v[160:163], v3 offset:18432
    s_waitcnt lgkmcnt(12)
    v_mfma_f32_16x16x32_bf16 v[48:51], v[136:139], v[128:131], v[48:51]
    ds_read_b128 v[164:167], v3 offset:20480
    v_mfma_f32_16x16x32_bf16 v[40:43], v[136:139], v[124:127], v[40:43]
    ds_read_b128 v[168:171], v3 offset:22528
    v_mfma_f32_16x16x32_bf16 v[32:35], v[136:139], v[120:123], v[32:35]
    ds_read_b64_tr_b16 v[176:177], v5 offset:36864
    v_mfma_f32_16x16x32_bf16 v[24:27], v[136:139], v[116:119], v[24:27]
    ds_read_b64_tr_b16 v[178:179], v5 offset:37376
    s_waitcnt lgkmcnt(14)
    v_mfma_f32_16x16x32_bf16 v[52:55], v[140:143], v[116:119], v[52:55]
    ds_read_b64_tr_b16 v[180:181], v4 offset:37888
    v_mfma_f32_16x16x32_bf16 v[60:63], v[140:143], v[120:123], v[60:63]
    ds_read_b64_tr_b16 v[182:183], v4 offset:38400
    v_mfma_f32_16x16x32_bf16 v[68:71], v[140:143], v[124:127], v[68:71]
    ds_read_b64_tr_b16 v[184:185], v5 offset:37888
    v_mfma_f32_16x16x32_bf16 v[76:79], v[140:143], v[128:131], v[76:79]
    ds_read_b64_tr_b16 v[186:187], v5 offset:38400
    s_waitcnt lgkmcnt(15)
    v_mfma_f32_16x16x32_bf16 v[80:83], v[144:147], v[128:131], v[80:83]
    ds_read_b64_tr_b16 v[188:189], v4 offset:38912
    v_mfma_f32_16x16x32_bf16 v[72:75], v[144:147], v[124:127], v[72:75]
    ds_read_b64_tr_b16 v[190:191], v4 offset:39424
    v_mfma_f32_16x16x32_bf16 v[64:67], v[144:147], v[120:123], v[64:67]
    ds_read_b64_tr_b16 v[192:193], v5 offset:38912
    v_mfma_f32_16x16x32_bf16 v[56:59], v[144:147], v[116:119], v[56:59]
    ds_read_b64_tr_b16 v[194:195], v5 offset:39424
    s_waitcnt lgkmcnt(15)
    v_mfma_f32_16x16x32_bf16 v[84:87], v[148:151], v[116:119], v[84:87]
    v_mfma_f32_16x16x32_bf16 v[92:95], v[148:151], v[120:123], v[92:95]
    v_mfma_f32_16x16x32_bf16 v[100:103], v[148:151], v[124:127], v[100:103]
    v_mfma_f32_16x16x32_bf16 v[108:111], v[148:151], v[128:131], v[108:111]
    s_waitcnt lgkmcnt(15)
    v_mfma_f32_16x16x32_bf16 v[112:115], v[152:155], v[128:131], v[112:115]
    v_mfma_f32_16x16x32_bf16 v[104:107], v[152:155], v[124:127], v[104:107]
    v_mfma_f32_16x16x32_bf16 v[96:99], v[152:155], v[120:123], v[96:99]
    v_mfma_f32_16x16x32_bf16 v[88:91], v[152:155], v[116:119], v[88:91]
    s_waitcnt lgkmcnt(0)
    ds_write_b32 v14, v15
    v_mfma_f32_16x16x32_bf16 v[20:23], v[172:175], v[156:159], v[20:23]
    ds_read_b32 v230, v243 offset:0
    v_mfma_f32_16x16x32_bf16 v[28:31], v[172:175], v[160:163], v[28:31]
    ds_read_b32 v232, v243 offset:64
    v_mfma_f32_16x16x32_bf16 v[36:39], v[172:175], v[164:167], v[36:39]
    ds_read_b32 v234, v243 offset:128
    v_mfma_f32_16x16x32_bf16 v[44:47], v[172:175], v[168:171], v[44:47]
    ds_read_b32 v236, v243 offset:192
    v_mfma_f32_16x16x32_bf16 v[48:51], v[176:179], v[168:171], v[48:51]
    ds_read_b32 v6, v243 offset:512
    v_mfma_f32_16x16x32_bf16 v[40:43], v[176:179], v[164:167], v[40:43]
    ds_read_b32 v8, v243 offset:576
    v_mfma_f32_16x16x32_bf16 v[32:35], v[176:179], v[160:163], v[32:35]
    ds_read_b32 v10, v243 offset:640
    v_mfma_f32_16x16x32_bf16 v[24:27], v[176:179], v[156:159], v[24:27]
    ds_read_b32 v12, v243 offset:704
    v_mfma_f32_16x16x32_bf16 v[52:55], v[180:183], v[156:159], v[52:55]
    ds_read_b128 v[116:119], v238 offset:0
    v_mfma_f32_16x16x32_bf16 v[60:63], v[180:183], v[160:163], v[60:63]
    ds_read_b128 v[120:123], v238 offset:64
    v_mfma_f32_16x16x32_bf16 v[68:71], v[180:183], v[164:167], v[68:71]
    ds_read_b128 v[124:127], v238 offset:768
    v_mfma_f32_16x16x32_bf16 v[76:79], v[180:183], v[168:171], v[76:79]
    ds_read_b128 v[128:131], v238 offset:832
    v_mfma_f32_16x16x32_bf16 v[80:83], v[184:187], v[168:171], v[80:83]
    v_mfma_f32_16x16x32_bf16 v[72:75], v[184:187], v[164:167], v[72:75]
    v_mfma_f32_16x16x32_bf16 v[64:67], v[184:187], v[160:163], v[64:67]
    v_mfma_f32_16x16x32_bf16 v[56:59], v[184:187], v[156:159], v[56:59]
    v_mfma_f32_16x16x32_bf16 v[84:87], v[188:191], v[156:159], v[84:87]
    v_mfma_f32_16x16x32_bf16 v[92:95], v[188:191], v[160:163], v[92:95]
    v_mfma_f32_16x16x32_bf16 v[100:103], v[188:191], v[164:167], v[100:103]
    v_mfma_f32_16x16x32_bf16 v[108:111], v[188:191], v[168:171], v[108:111]
    v_mfma_f32_16x16x32_bf16 v[112:115], v[192:195], v[168:171], v[112:115]
    v_mfma_f32_16x16x32_bf16 v[104:107], v[192:195], v[164:167], v[104:107]
    v_mfma_f32_16x16x32_bf16 v[96:99], v[192:195], v[160:163], v[96:99]
    v_mfma_f32_16x16x32_bf16 v[88:91], v[192:195], v[156:159], v[88:91]
L_Cepi:
    s_add_u32 s78, s76, s54
    s_lshl_b32 s78, s78, 10
    s_add_u32 s75, s75, s78
    s_waitcnt lgkmcnt(4)
    v_mul_f32 v230, v230, v6
    v_mul_f32 v232, v232, v8
    v_mul_f32 v234, v234, v10
    v_mul_f32 v236, v236, v12
    s_waitcnt lgkmcnt(0)
    ds_read_b128 v[132:135], v238 offset:256
    ds_read_b128 v[136:139], v238 offset:320
    ds_read_b128 v[140:143], v238 offset:1024
    ds_read_b128 v[144:147], v238 offset:1088
    .p2align 3
    v_pk_fma_f32 v[156:157], v[230:231], v[116:117], v[124:125] op_sel_hi:[0,1,1] neg_lo:[1,0,0] neg_hi:[1,0,0]
    v_pk_fma_f32 v[158:159], v[230:231], v[118:119], v[126:127] op_sel_hi:[0,1,1] neg_lo:[1,0,0] neg_hi:[1,0,0]
    v_pk_fma_f32 v[160:161], v[230:231], v[120:121], v[128:129] op_sel_hi:[0,1,1] neg_lo:[1,0,0] neg_hi:[1,0,0]
    v_pk_fma_f32 v[162:163], v[230:231], v[122:123], v[130:131] op_sel_hi:[0,1,1] neg_lo:[1,0,0] neg_hi:[1,0,0]
    v_pk_fma_f32 v[164:165], v[232:233], v[116:117], v[124:125] op_sel_hi:[0,1,1] neg_lo:[1,0,0] neg_hi:[1,0,0]
    v_pk_fma_f32 v[166:167], v[232:233], v[118:119], v[126:127] op_sel_hi:[0,1,1] neg_lo:[1,0,0] neg_hi:[1,0,0]
    v_pk_fma_f32 v[168:169], v[232:233], v[120:121], v[128:129] op_sel_hi:[0,1,1] neg_lo:[1,0,0] neg_hi:[1,0,0]
    v_pk_fma_f32 v[170:171], v[232:233], v[122:123], v[130:131] op_sel_hi:[0,1,1] neg_lo:[1,0,0] neg_hi:[1,0,0]
    v_pk_fma_f32 v[20:21], v[20:21], v[6:7], v[156:157] op_sel_hi:[1,0,1]
    v_pk_fma_f32 v[22:23], v[22:23], v[6:7], v[158:159] op_sel_hi:[1,0,1]
    v_pk_fma_f32 v[24:25], v[24:25], v[6:7], v[160:161] op_sel_hi:[1,0,1]
    v_pk_fma_f32 v[26:27], v[26:27], v[6:7], v[162:163] op_sel_hi:[1,0,1]
    v_pk_fma_f32 v[28:29], v[28:29], v[8:9], v[164:165] op_sel_hi:[1,0,1]
    v_pk_fma_f32 v[30:31], v[30:31], v[8:9], v[166:167] op_sel_hi:[1,0,1]
    v_pk_fma_f32 v[32:33], v[32:33], v[8:9], v[168:169] op_sel_hi:[1,0,1]
    v_pk_fma_f32 v[34:35], v[34:35], v[8:9], v[170:171] op_sel_hi:[1,0,1]
    v_exp_f32 v172, v20
    v_exp_f32 v173, v21
    v_exp_f32 v174, v22
    v_exp_f32 v175, v23
    v_exp_f32 v176, v24
    v_exp_f32 v177, v25
    v_exp_f32 v178, v26
    v_exp_f32 v179, v27
    v_exp_f32 v180, v28
    v_exp_f32 v181, v29
    v_exp_f32 v182, v30
    v_exp_f32 v183, v31
    v_exp_f32 v184, v32
    v_exp_f32 v185, v33
    v_exp_f32 v186, v34
    v_exp_f32 v187, v35
    v_pk_fma_f32 v[156:157], v[172:173], v[220:221], v[226:227] op_sel_hi:[1,0,0]
    v_pk_fma_f32 v[158:159], v[174:175], v[220:221], v[226:227] op_sel_hi:[1,0,0]
    v_pk_fma_f32 v[160:161], v[176:177], v[220:221], v[226:227] op_sel_hi:[1,0,0]
    v_pk_fma_f32 v[162:163], v[178:179], v[220:221], v[226:227] op_sel_hi:[1,0,0]
    v_pk_fma_f32 v[164:165], v[180:181], v[220:221], v[226:227] op_sel_hi:[1,0,0]
    v_pk_fma_f32 v[166:167], v[182:183], v[220:221], v[226:227] op_sel_hi:[1,0,0]
    v_pk_fma_f32 v[168:169], v[184:185], v[220:221], v[226:227] op_sel_hi:[1,0,0]
    v_pk_fma_f32 v[170:171], v[186:187], v[220:221], v[226:227] op_sel_hi:[1,0,0]
    v_pk_fma_f32 v[172:173], v[172:173], v[156:157], v[226:227] op_sel_hi:[1,1,0]
    v_pk_fma_f32 v[174:175], v[174:175], v[158:159], v[226:227] op_sel_hi:[1,1,0]
    v_pk_fma_f32 v[176:177], v[176:177], v[160:161], v[226:227] op_sel_hi:[1,1,0]
    v_pk_fma_f32 v[178:179], v[178:179], v[162:163], v[226:227] op_sel_hi:[1,1,0]
    v_pk_fma_f32 v[180:181], v[180:181], v[164:165], v[226:227] op_sel_hi:[1,1,0]
    v_pk_fma_f32 v[182:183], v[182:183], v[166:167], v[226:227] op_sel_hi:[1,1,0]
    v_pk_fma_f32 v[184:185], v[184:185], v[168:169], v[226:227] op_sel_hi:[1,1,0]
    v_pk_fma_f32 v[186:187], v[186:187], v[170:171], v[226:227] op_sel_hi:[1,1,0]
    v_rcp_f32 v172, v172
    v_rcp_f32 v173, v173
    v_rcp_f32 v174, v174
    v_rcp_f32 v175, v175
    v_rcp_f32 v176, v176
    v_rcp_f32 v177, v177
    v_rcp_f32 v178, v178
    v_rcp_f32 v179, v179
    v_rcp_f32 v180, v180
    v_rcp_f32 v181, v181
    v_rcp_f32 v182, v182
    v_rcp_f32 v183, v183
    v_rcp_f32 v184, v184
    v_rcp_f32 v185, v185
    v_rcp_f32 v186, v186
    v_rcp_f32 v187, v187
    v_pk_fma_f32 v[172:173], v[20:21], v[172:173], v[20:21] neg_lo:[1,0,0] neg_hi:[1,0,0]
    v_pk_fma_f32 v[174:175], v[22:23], v[174:175], v[22:23] neg_lo:[1,0,0] neg_hi:[1,0,0]
    v_pk_fma_f32 v[176:177], v[24:25], v[176:177], v[24:25] neg_lo:[1,0,0] neg_hi:[1,0,0]
    v_pk_fma_f32 v[178:179], v[26:27], v[178:179], v[26:27] neg_lo:[1,0,0] neg_hi:[1,0,0]
    v_pk_fma_f32 v[180:181], v[28:29], v[180:181], v[28:29] neg_lo:[1,0,0] neg_hi:[1,0,0]
    v_pk_fma_f32 v[182:183], v[30:31], v[182:183], v[30:31] neg_lo:[1,0,0] neg_hi:[1,0,0]
    v_pk_fma_f32 v[184:185], v[32:33], v[184:185], v[32:33] neg_lo:[1,0,0] neg_hi:[1,0,0]
    v_pk_fma_f32 v[186:187], v[34:35], v[186:187], v[34:35] neg_lo:[1,0,0] neg_hi:[1,0,0]
    v_cvt_pk_bf16_f32 v20, v172, v173
    v_cvt_pk_bf16_f32 v21, v174, v175
    v_cvt_pk_bf16_f32 v22, v176, v177
    v_cvt_pk_bf16_f32 v23, v178, v179
    v_cvt_pk_bf16_f32 v24, v180, v181
    v_cvt_pk_bf16_f32 v25, v182, v183
    v_cvt_pk_bf16_f32 v26, v184, v185
    v_cvt_pk_bf16_f32 v27, v186, v187
    buffer_store_dwordx4 v[20:23], v1, s[40:43], s75 offen sc1
    buffer_store_dwordx4 v[24:27], v248, s[40:43], s75 offen sc1
    .p2align 3
    v_pk_fma_f32 v[156:157], v[234:235], v[116:117], v[124:125] op_sel_hi:[0,1,1] neg_lo:[1,0,0] neg_hi:[1,0,0]
    v_pk_fma_f32 v[158:159], v[234:235], v[118:119], v[126:127] op_sel_hi:[0,1,1] neg_lo:[1,0,0] neg_hi:[1,0,0]
    v_pk_fma_f32 v[160:161], v[234:235], v[120:121], v[128:129] op_sel_hi:[0,1,1] neg_lo:[1,0,0] neg_hi:[1,0,0]
    v_pk_fma_f32 v[162:163], v[234:235], v[122:123], v[130:131] op_sel_hi:[0,1,1] neg_lo:[1,0,0] neg_hi:[1,0,0]
    v_pk_fma_f32 v[164:165], v[236:237], v[116:117], v[124:125] op_sel_hi:[0,1,1] neg_lo:[1,0,0] neg_hi:[1,0,0]
    v_pk_fma_f32 v[166:167], v[236:237], v[118:119], v[126:127] op_sel_hi:[0,1,1] neg_lo:[1,0,0] neg_hi:[1,0,0]
    v_pk_fma_f32 v[168:169], v[236:237], v[120:121], v[128:129] op_sel_hi:[0,1,1] neg_lo:[1,0,0] neg_hi:[1,0,0]
    v_pk_fma_f32 v[170:171], v[236:237], v[122:123], v[130:131] op_sel_hi:[0,1,1] neg_lo:[1,0,0] neg_hi:[1,0,0]
    v_pk_fma_f32 v[36:37], v[36:37], v[10:11], v[156:157] op_sel_hi:[1,0,1]
    v_pk_fma_f32 v[38:39], v[38:39], v[10:11], v[158:159] op_sel_hi:[1,0,1]
    v_pk_fma_f32 v[40:41], v[40:41], v[10:11], v[160:161] op_sel_hi:[1,0,1]
    v_pk_fma_f32 v[42:43], v[42:43], v[10:11], v[162:163] op_sel_hi:[1,0,1]
    v_pk_fma_f32 v[44:45], v[44:45], v[12:13], v[164:165] op_sel_hi:[1,0,1]
    v_pk_fma_f32 v[46:47], v[46:47], v[12:13], v[166:167] op_sel_hi:[1,0,1]
    v_pk_fma_f32 v[48:49], v[48:49], v[12:13], v[168:169] op_sel_hi:[1,0,1]
    v_pk_fma_f32 v[50:51], v[50:51], v[12:13], v[170:171] op_sel_hi:[1,0,1]
    v_exp_f32 v172, v36
    v_exp_f32 v173, v37
    v_exp_f32 v174, v38
    v_exp_f32 v175, v39
    v_exp_f32 v176, v40
    v_exp_f32 v177, v41
    v_exp_f32 v178, v42
    v_exp_f32 v179, v43
    v_exp_f32 v180, v44
    v_exp_f32 v181, v45
    v_exp_f32 v182, v46
    v_exp_f32 v183, v47
    v_exp_f32 v184, v48
    v_exp_f32 v185, v49
    v_exp_f32 v186, v50
    v_exp_f32 v187, v51
    v_pk_fma_f32 v[156:157], v[172:173], v[220:221], v[226:227] op_sel_hi:[1,0,0]
    v_pk_fma_f32 v[158:159], v[174:175], v[220:221], v[226:227] op_sel_hi:[1,0,0]
    v_pk_fma_f32 v[160:161], v[176:177], v[220:221], v[226:227] op_sel_hi:[1,0,0]
    v_pk_fma_f32 v[162:163], v[178:179], v[220:221], v[226:227] op_sel_hi:[1,0,0]
    v_pk_fma_f32 v[164:165], v[180:181], v[220:221], v[226:227] op_sel_hi:[1,0,0]
    v_pk_fma_f32 v[166:167], v[182:183], v[220:221], v[226:227] op_sel_hi:[1,0,0]
    v_pk_fma_f32 v[168:169], v[184:185], v[220:221], v[226:227] op_sel_hi:[1,0,0]
    v_pk_fma_f32 v[170:171], v[186:187], v[220:221], v[226:227] op_sel_hi:[1,0,0]
    v_pk_fma_f32 v[172:173], v[172:173], v[156:157], v[226:227] op_sel_hi:[1,1,0]
    v_pk_fma_f32 v[174:175], v[174:175], v[158:159], v[226:227] op_sel_hi:[1,1,0]
    v_pk_fma_f32 v[176:177], v[176:177], v[160:161], v[226:227] op_sel_hi:[1,1,0]
    v_pk_fma_f32 v[178:179], v[178:179], v[162:163], v[226:227] op_sel_hi:[1,1,0]
    v_pk_fma_f32 v[180:181], v[180:181], v[164:165], v[226:227] op_sel_hi:[1,1,0]
    v_pk_fma_f32 v[182:183], v[182:183], v[166:167], v[226:227] op_sel_hi:[1,1,0]
    v_pk_fma_f32 v[184:185], v[184:185], v[168:169], v[226:227] op_sel_hi:[1,1,0]
    v_pk_fma_f32 v[186:187], v[186:187], v[170:171], v[226:227] op_sel_hi:[1,1,0]
    v_rcp_f32 v172, v172
    v_rcp_f32 v173, v173
    v_rcp_f32 v174, v174
    v_rcp_f32 v175, v175
    v_rcp_f32 v176, v176
    v_rcp_f32 v177, v177
    v_rcp_f32 v178, v178
    v_rcp_f32 v179, v179
    v_rcp_f32 v180, v180
    v_rcp_f32 v181, v181
    v_rcp_f32 v182, v182
    v_rcp_f32 v183, v183
    v_rcp_f32 v184, v184
    v_rcp_f32 v185, v185
    v_rcp_f32 v186, v186
    v_rcp_f32 v187, v187
    v_pk_fma_f32 v[172:173], v[36:37], v[172:173], v[36:37] neg_lo:[1,0,0] neg_hi:[1,0,0]
    v_pk_fma_f32 v[174:175], v[38:39], v[174:175], v[38:39] neg_lo:[1,0,0] neg_hi:[1,0,0]
    v_pk_fma_f32 v[176:177], v[40:41], v[176:177], v[40:41] neg_lo:[1,0,0] neg_hi:[1,0,0]
    v_pk_fma_f32 v[178:179], v[42:43], v[178:179], v[42:43] neg_lo:[1,0,0] neg_hi:[1,0,0]
    v_pk_fma_f32 v[180:181], v[44:45], v[180:181], v[44:45] neg_lo:[1,0,0] neg_hi:[1,0,0]
    v_pk_fma_f32 v[182:183], v[46:47], v[182:183], v[46:47] neg_lo:[1,0,0] neg_hi:[1,0,0]
    v_pk_fma_f32 v[184:185], v[48:49], v[184:185], v[48:49] neg_lo:[1,0,0] neg_hi:[1,0,0]
    v_pk_fma_f32 v[186:187], v[50:51], v[186:187], v[50:51] neg_lo:[1,0,0] neg_hi:[1,0,0]
    v_cvt_pk_bf16_f32 v36, v172, v173
    v_cvt_pk_bf16_f32 v37, v174, v175
    v_cvt_pk_bf16_f32 v38, v176, v177
    v_cvt_pk_bf16_f32 v39, v178, v179
    v_cvt_pk_bf16_f32 v40, v180, v181
    v_cvt_pk_bf16_f32 v41, v182, v183
    v_cvt_pk_bf16_f32 v42, v184, v185
    v_cvt_pk_bf16_f32 v43, v186, v187
    buffer_store_dwordx4 v[36:39], v16, s[40:43], s75 offen sc1
    buffer_store_dwordx4 v[40:43], v255, s[40:43], s75 offen sc1
    s_waitcnt lgkmcnt(0)
    ds_read_b128 v[116:119], v238 offset:512
    ds_read_b128 v[120:123], v238 offset:576
    ds_read_b128 v[124:127], v238 offset:1280
    ds_read_b128 v[128:131], v238 offset:1344
    .p2align 3
    v_pk_fma_f32 v[156:157], v[230:231], v[132:133], v[140:141] op_sel_hi:[0,1,1] neg_lo:[1,0,0] neg_hi:[1,0,0]
    v_pk_fma_f32 v[158:159], v[230:231], v[134:135], v[142:143] op_sel_hi:[0,1,1] neg_lo:[1,0,0] neg_hi:[1,0,0]
    v_pk_fma_f32 v[160:161], v[230:231], v[136:137], v[144:145] op_sel_hi:[0,1,1] neg_lo:[1,0,0] neg_hi:[1,0,0]
    v_pk_fma_f32 v[162:163], v[230:231], v[138:139], v[146:147] op_sel_hi:[0,1,1] neg_lo:[1,0,0] neg_hi:[1,0,0]
    v_pk_fma_f32 v[164:165], v[232:233], v[132:133], v[140:141] op_sel_hi:[0,1,1] neg_lo:[1,0,0] neg_hi:[1,0,0]
    v_pk_fma_f32 v[166:167], v[232:233], v[134:135], v[142:143] op_sel_hi:[0,1,1] neg_lo:[1,0,0] neg_hi:[1,0,0]
    v_pk_fma_f32 v[168:169], v[232:233], v[136:137], v[144:145] op_sel_hi:[0,1,1] neg_lo:[1,0,0] neg_hi:[1,0,0]
    v_pk_fma_f32 v[170:171], v[232:233], v[138:139], v[146:147] op_sel_hi:[0,1,1] neg_lo:[1,0,0] neg_hi:[1,0,0]
    v_pk_fma_f32 v[52:53], v[52:53], v[6:7], v[156:157] op_sel_hi:[1,0,1]
    v_pk_fma_f32 v[54:55], v[54:55], v[6:7], v[158:159] op_sel_hi:[1,0,1]
    v_pk_fma_f32 v[56:57], v[56:57], v[6:7], v[160:161] op_sel_hi:[1,0,1]
    v_pk_fma_f32 v[58:59], v[58:59], v[6:7], v[162:163] op_sel_hi:[1,0,1]
    v_pk_fma_f32 v[60:61], v[60:61], v[8:9], v[164:165] op_sel_hi:[1,0,1]
    v_pk_fma_f32 v[62:63], v[62:63], v[8:9], v[166:167] op_sel_hi:[1,0,1]
    v_pk_fma_f32 v[64:65], v[64:65], v[8:9], v[168:169] op_sel_hi:[1,0,1]
    v_pk_fma_f32 v[66:67], v[66:67], v[8:9], v[170:171] op_sel_hi:[1,0,1]
    v_exp_f32 v172, v52
    v_exp_f32 v173, v53
    v_exp_f32 v174, v54
    v_exp_f32 v175, v55
    v_exp_f32 v176, v56
    v_exp_f32 v177, v57
    v_exp_f32 v178, v58
    v_exp_f32 v179, v59
    v_exp_f32 v180, v60
    v_exp_f32 v181, v61
    v_exp_f32 v182, v62
    v_exp_f32 v183, v63
    v_exp_f32 v184, v64
    v_exp_f32 v185, v65
    v_exp_f32 v186, v66
    v_exp_f32 v187, v67
    v_pk_fma_f32 v[156:157], v[172:173], v[220:221], v[226:227] op_sel_hi:[1,0,0]
    v_pk_fma_f32 v[158:159], v[174:175], v[220:221], v[226:227] op_sel_hi:[1,0,0]
    v_pk_fma_f32 v[160:161], v[176:177], v[220:221], v[226:227] op_sel_hi:[1,0,0]
    v_pk_fma_f32 v[162:163], v[178:179], v[220:221], v[226:227] op_sel_hi:[1,0,0]
    v_pk_fma_f32 v[164:165], v[180:181], v[220:221], v[226:227] op_sel_hi:[1,0,0]
    v_pk_fma_f32 v[166:167], v[182:183], v[220:221], v[226:227] op_sel_hi:[1,0,0]
    v_pk_fma_f32 v[168:169], v[184:185], v[220:221], v[226:227] op_sel_hi:[1,0,0]
    v_pk_fma_f32 v[170:171], v[186:187], v[220:221], v[226:227] op_sel_hi:[1,0,0]
    v_pk_fma_f32 v[172:173], v[172:173], v[156:157], v[226:227] op_sel_hi:[1,1,0]
    v_pk_fma_f32 v[174:175], v[174:175], v[158:159], v[226:227] op_sel_hi:[1,1,0]
    v_pk_fma_f32 v[176:177], v[176:177], v[160:161], v[226:227] op_sel_hi:[1,1,0]
    v_pk_fma_f32 v[178:179], v[178:179], v[162:163], v[226:227] op_sel_hi:[1,1,0]
    v_pk_fma_f32 v[180:181], v[180:181], v[164:165], v[226:227] op_sel_hi:[1,1,0]
    v_pk_fma_f32 v[182:183], v[182:183], v[166:167], v[226:227] op_sel_hi:[1,1,0]
    v_pk_fma_f32 v[184:185], v[184:185], v[168:169], v[226:227] op_sel_hi:[1,1,0]
    v_pk_fma_f32 v[186:187], v[186:187], v[170:171], v[226:227] op_sel_hi:[1,1,0]
    v_rcp_f32 v172, v172
    v_rcp_f32 v173, v173
    v_rcp_f32 v174, v174
    v_rcp_f32 v175, v175
    v_rcp_f32 v176, v176
    v_rcp_f32 v177, v177
    v_rcp_f32 v178, v178
    v_rcp_f32 v179, v179
    v_rcp_f32 v180, v180
    v_rcp_f32 v181, v181
    v_rcp_f32 v182, v182
    v_rcp_f32 v183, v183
    v_rcp_f32 v184, v184
    v_rcp_f32 v185, v185
    v_rcp_f32 v186, v186
    v_rcp_f32 v187, v187
    v_pk_fma_f32 v[172:173], v[52:53], v[172:173], v[52:53] neg_lo:[1,0,0] neg_hi:[1,0,0]
    v_pk_fma_f32 v[174:175], v[54:55], v[174:175], v[54:55] neg_lo:[1,0,0] neg_hi:[1,0,0]
    v_pk_fma_f32 v[176:177], v[56:57], v[176:177], v[56:57] neg_lo:[1,0,0] neg_hi:[1,0,0]
    v_pk_fma_f32 v[178:179], v[58:59], v[178:179], v[58:59] neg_lo:[1,0,0] neg_hi:[1,0,0]
    v_pk_fma_f32 v[180:181], v[60:61], v[180:181], v[60:61] neg_lo:[1,0,0] neg_hi:[1,0,0]
    v_pk_fma_f32 v[182:183], v[62:63], v[182:183], v[62:63] neg_lo:[1,0,0] neg_hi:[1,0,0]
    v_pk_fma_f32 v[184:185], v[64:65], v[184:185], v[64:65] neg_lo:[1,0,0] neg_hi:[1,0,0]
    v_pk_fma_f32 v[186:187], v[66:67], v[186:187], v[66:67] neg_lo:[1,0,0] neg_hi:[1,0,0]
    v_cvt_pk_bf16_f32 v52, v172, v173
    v_cvt_pk_bf16_f32 v53, v174, v175
    v_cvt_pk_bf16_f32 v54, v176, v177
    v_cvt_pk_bf16_f32 v55, v178, v179
    v_cvt_pk_bf16_f32 v56, v180, v181
    v_cvt_pk_bf16_f32 v57, v182, v183
    v_cvt_pk_bf16_f32 v58, v184, v185
    v_cvt_pk_bf16_f32 v59, v186, v187
    buffer_store_dwordx4 v[52:55], v1, s[40:43], s75 offen offset:2048 sc1
    buffer_store_dwordx4 v[56:59], v248, s[40:43], s75 offen offset:2048 sc1
    .p2align 3
    v_pk_fma_f32 v[156:157], v[234:235], v[132:133], v[140:141] op_sel_hi:[0,1,1] neg_lo:[1,0,0] neg_hi:[1,0,0]
    v_pk_fma_f32 v[158:159], v[234:235], v[134:135], v[142:143] op_sel_hi:[0,1,1] neg_lo:[1,0,0] neg_hi:[1,0,0]
    v_pk_fma_f32 v[160:161], v[234:235], v[136:137], v[144:145] op_sel_hi:[0,1,1] neg_lo:[1,0,0] neg_hi:[1,0,0]
    v_pk_fma_f32 v[162:163], v[234:235], v[138:139], v[146:147] op_sel_hi:[0,1,1] neg_lo:[1,0,0] neg_hi:[1,0,0]
    v_pk_fma_f32 v[164:165], v[236:237], v[132:133], v[140:141] op_sel_hi:[0,1,1] neg_lo:[1,0,0] neg_hi:[1,0,0]
    v_pk_fma_f32 v[166:167], v[236:237], v[134:135], v[142:143] op_sel_hi:[0,1,1] neg_lo:[1,0,0] neg_hi:[1,0,0]
    v_pk_fma_f32 v[168:169], v[236:237], v[136:137], v[144:145] op_sel_hi:[0,1,1] neg_lo:[1,0,0] neg_hi:[1,0,0]
    v_pk_fma_f32 v[170:171], v[236:237], v[138:139], v[146:147] op_sel_hi:[0,1,1] neg_lo:[1,0,0] neg_hi:[1,0,0]
    v_pk_fma_f32 v[68:69], v[68:69], v[10:11], v[156:157] op_sel_hi:[1,0,1]
    v_pk_fma_f32 v[70:71], v[70:71], v[10:11], v[158:159] op_sel_hi:[1,0,1]
    v_pk_fma_f32 v[72:73], v[72:73], v[10:11], v[160:161] op_sel_hi:[1,0,1]
    v_pk_fma_f32 v[74:75], v[74:75], v[10:11], v[162:163] op_sel_hi:[1,0,1]
    v_pk_fma_f32 v[76:77], v[76:77], v[12:13], v[164:165] op_sel_hi:[1,0,1]
    v_pk_fma_f32 v[78:79], v[78:79], v[12:13], v[166:167] op_sel_hi:[1,0,1]
    v_pk_fma_f32 v[80:81], v[80:81], v[12:13], v[168:169] op_sel_hi:[1,0,1]
    v_pk_fma_f32 v[82:83], v[82:83], v[12:13], v[170:171] op_sel_hi:[1,0,1]
    v_exp_f32 v172, v68
    v_exp_f32 v173, v69
    v_exp_f32 v174, v70
    v_exp_f32 v175, v71
    v_exp_f32 v176, v72
    v_exp_f32 v177, v73
    v_exp_f32 v178, v74
    v_exp_f32 v179, v75
    v_exp_f32 v180, v76
    v_exp_f32 v181, v77
    v_exp_f32 v182, v78
    v_exp_f32 v183, v79
    v_exp_f32 v184, v80
    v_exp_f32 v185, v81
    v_exp_f32 v186, v82
    v_exp_f32 v187, v83
    v_pk_fma_f32 v[156:157], v[172:173], v[220:221], v[226:227] op_sel_hi:[1,0,0]
    v_pk_fma_f32 v[158:159], v[174:175], v[220:221], v[226:227] op_sel_hi:[1,0,0]
    v_pk_fma_f32 v[160:161], v[176:177], v[220:221], v[226:227] op_sel_hi:[1,0,0]
    v_pk_fma_f32 v[162:163], v[178:179], v[220:221], v[226:227] op_sel_hi:[1,0,0]
    v_pk_fma_f32 v[164:165], v[180:181], v[220:221], v[226:227] op_sel_hi:[1,0,0]
    v_pk_fma_f32 v[166:167], v[182:183], v[220:221], v[226:227] op_sel_hi:[1,0,0]
    v_pk_fma_f32 v[168:169], v[184:185], v[220:221], v[226:227] op_sel_hi:[1,0,0]
    v_pk_fma_f32 v[170:171], v[186:187], v[220:221], v[226:227] op_sel_hi:[1,0,0]
    v_pk_fma_f32 v[172:173], v[172:173], v[156:157], v[226:227] op_sel_hi:[1,1,0]
    v_pk_fma_f32 v[174:175], v[174:175], v[158:159], v[226:227] op_sel_hi:[1,1,0]
    v_pk_fma_f32 v[176:177], v[176:177], v[160:161], v[226:227] op_sel_hi:[1,1,0]
    v_pk_fma_f32 v[178:179], v[178:179], v[162:163], v[226:227] op_sel_hi:[1,1,0]
    v_pk_fma_f32 v[180:181], v[180:181], v[164:165], v[226:227] op_sel_hi:[1,1,0]
    v_pk_fma_f32 v[182:183], v[182:183], v[166:167], v[226:227] op_sel_hi:[1,1,0]
    v_pk_fma_f32 v[184:185], v[184:185], v[168:169], v[226:227] op_sel_hi:[1,1,0]
    v_pk_fma_f32 v[186:187], v[186:187], v[170:171], v[226:227] op_sel_hi:[1,1,0]
    v_rcp_f32 v172, v172
    v_rcp_f32 v173, v173
    v_rcp_f32 v174, v174
    v_rcp_f32 v175, v175
    v_rcp_f32 v176, v176
    v_rcp_f32 v177, v177
    v_rcp_f32 v178, v178
    v_rcp_f32 v179, v179
    v_rcp_f32 v180, v180
    v_rcp_f32 v181, v181
    v_rcp_f32 v182, v182
    v_rcp_f32 v183, v183
    v_rcp_f32 v184, v184
    v_rcp_f32 v185, v185
    v_rcp_f32 v186, v186
    v_rcp_f32 v187, v187
    v_pk_fma_f32 v[172:173], v[68:69], v[172:173], v[68:69] neg_lo:[1,0,0] neg_hi:[1,0,0]
    v_pk_fma_f32 v[174:175], v[70:71], v[174:175], v[70:71] neg_lo:[1,0,0] neg_hi:[1,0,0]
    v_pk_fma_f32 v[176:177], v[72:73], v[176:177], v[72:73] neg_lo:[1,0,0] neg_hi:[1,0,0]
    v_pk_fma_f32 v[178:179], v[74:75], v[178:179], v[74:75] neg_lo:[1,0,0] neg_hi:[1,0,0]
    v_pk_fma_f32 v[180:181], v[76:77], v[180:181], v[76:77] neg_lo:[1,0,0] neg_hi:[1,0,0]
    v_pk_fma_f32 v[182:183], v[78:79], v[182:183], v[78:79] neg_lo:[1,0,0] neg_hi:[1,0,0]
    v_pk_fma_f32 v[184:185], v[80:81], v[184:185], v[80:81] neg_lo:[1,0,0] neg_hi:[1,0,0]
    v_pk_fma_f32 v[186:187], v[82:83], v[186:187], v[82:83] neg_lo:[1,0,0] neg_hi:[1,0,0]
    v_cvt_pk_bf16_f32 v68, v172, v173
    v_cvt_pk_bf16_f32 v69, v174, v175
    v_cvt_pk_bf16_f32 v70, v176, v177
    v_cvt_pk_bf16_f32 v71, v178, v179
    v_cvt_pk_bf16_f32 v72, v180, v181
    v_cvt_pk_bf16_f32 v73, v182, v183
    v_cvt_pk_bf16_f32 v74, v184, v185
    v_cvt_pk_bf16_f32 v75, v186, v187
    buffer_store_dwordx4 v[68:71], v16, s[40:43], s75 offen offset:2048 sc1
    buffer_store_dwordx4 v[72:75], v255, s[40:43], s75 offen offset:2048 sc1
    s_cmp_ge_u32 s56, 11
    s_cselect_b32 s77, s54, 0
    s_cmp_eq_u32 s77, 1
    s_cbranch_scc1 L_mlp_short
    s_waitcnt lgkmcnt(0)
    .p2align 3
    v_pk_fma_f32 v[156:157], v[230:231], v[116:117], v[124:125] op_sel_hi:[0,1,1] neg_lo:[1,0,0] neg_hi:[1,0,0]
    v_pk_fma_f32 v[158:159], v[230:231], v[118:119], v[126:127] op_sel_hi:[0,1,1] neg_lo:[1,0,0] neg_hi:[1,0,0]
    v_pk_fma_f32 v[160:161], v[230:231], v[120:121], v[128:129] op_sel_hi:[0,1,1] neg_lo:[1,0,0] neg_hi:[1,0,0]
    v_pk_fma_f32 v[162:163], v[230:231], v[122:123], v[130:131] op_sel_hi:[0,1,1] neg_lo:[1,0,0] neg_hi:[1,0,0]
    v_pk_fma_f32 v[164:165], v[232:233], v[116:117], v[124:125] op_sel_hi:[0,1,1] neg_lo:[1,0,0] neg_hi:[1,0,0]
    v_pk_fma_f32 v[166:167], v[232:233], v[118:119], v[126:127] op_sel_hi:[0,1,1] neg_lo:[1,0,0] neg_hi:[1,0,0]
    v_pk_fma_f32 v[168:169], v[232:233], v[120:121], v[128:129] op_sel_hi:[0,1,1] neg_lo:[1,0,0] neg_hi:[1,0,0]
    v_pk_fma_f32 v[170:171], v[232:233], v[122:123], v[130:131] op_sel_hi:[0,1,1] neg_lo:[1,0,0] neg_hi:[1,0,0]
    v_pk_fma_f32 v[84:85], v[84:85], v[6:7], v[156:157] op_sel_hi:[1,0,1]
    v_pk_fma_f32 v[86:87], v[86:87], v[6:7], v[158:159] op_sel_hi:[1,0,1]
    v_pk_fma_f32 v[88:89], v[88:89], v[6:7], v[160:161] op_sel_hi:[1,0,1]
    v_pk_fma_f32 v[90:91], v[90:91], v[6:7], v[162:163] op_sel_hi:[1,0,1]
    v_pk_fma_f32 v[92:93], v[92:93], v[8:9], v[164:165] op_sel_hi:[1,0,1]
    v_pk_fma_f32 v[94:95], v[94:95], v[8:9], v[166:167] op_sel_hi:[1,0,1]
    v_pk_fma_f32 v[96:97], v[96:97], v[8:9], v[168:169] op_sel_hi:[1,0,1]
    v_pk_fma_f32 v[98:99], v[98:99], v[8:9], v[170:171] op_sel_hi:[1,0,1]
    v_exp_f32 v172, v84
    v_exp_f32 v173, v85
    v_exp_f32 v174, v86
    v_exp_f32 v175, v87
    v_exp_f32 v176, v88
    v_exp_f32 v177, v89
    v_exp_f32 v178, v90
    v_exp_f32 v179, v91
    v_exp_f32 v180, v92
    v_exp_f32 v181, v93
    v_exp_f32 v182, v94
    v_exp_f32 v183, v95
    v_exp_f32 v184, v96
    v_exp_f32 v185, v97
    v_exp_f32 v186, v98
    v_exp_f32 v187, v99
    v_pk_fma_f32 v[156:157], v[172:173], v[220:221], v[226:227] op_sel_hi:[1,0,0]
    v_pk_fma_f32 v[158:159], v[174:175], v[220:221], v[226:227] op_sel_hi:[1,0,0]
    v_pk_fma_f32 v[160:161], v[176:177], v[220:221], v[226:227] op_sel_hi:[1,0,0]
    v_pk_fma_f32 v[162:163], v[178:179], v[220:221], v[226:227] op_sel_hi:[1,0,0]
    v_pk_fma_f32 v[164:165], v[180:181], v[220:221], v[226:227] op_sel_hi:[1,0,0]
    v_pk_fma_f32 v[166:167], v[182:183], v[220:221], v[226:227] op_sel_hi:[1,0,0]
    v_pk_fma_f32 v[168:169], v[184:185], v[220:221], v[226:227] op_sel_hi:[1,0,0]
    v_pk_fma_f32 v[170:171], v[186:187], v[220:221], v[226:227] op_sel_hi:[1,0,0]
    v_pk_fma_f32 v[172:173], v[172:173], v[156:157], v[226:227] op_sel_hi:[1,1,0]
    v_pk_fma_f32 v[174:175], v[174:175], v[158:159], v[226:227] op_sel_hi:[1,1,0]
    v_pk_fma_f32 v[176:177], v[176:177], v[160:161], v[226:227] op_sel_hi:[1,1,0]
    v_pk_fma_f32 v[178:179], v[178:179], v[162:163], v[226:227] op_sel_hi:[1,1,0]
    v_pk_fma_f32 v[180:181], v[180:181], v[164:165], v[226:227] op_sel_hi:[1,1,0]
    v_pk_fma_f32 v[182:183], v[182:183], v[166:167], v[226:227] op_sel_hi:[1,1,0]
    v_pk_fma_f32 v[184:185], v[184:185], v[168:169], v[226:227] op_sel_hi:[1,1,0]
    v_pk_fma_f32 v[186:187], v[186:187], v[170:171], v[226:227] op_sel_hi:[1,1,0]
    v_rcp_f32 v172, v172
    v_rcp_f32 v173, v173
    v_rcp_f32 v174, v174
    v_rcp_f32 v175, v175
    v_rcp_f32 v176, v176
    v_rcp_f32 v177, v177
    v_rcp_f32 v178, v178
    v_rcp_f32 v179, v179
    v_rcp_f32 v180, v180
    v_rcp_f32 v181, v181
    v_rcp_f32 v182, v182
    v_rcp_f32 v183, v183
    v_rcp_f32 v184, v184
    v_rcp_f32 v185, v185
    v_rcp_f32 v186, v186
    v_rcp_f32 v187, v187
    v_pk_fma_f32 v[172:173], v[84:85], v[172:173], v[84:85] neg_lo:[1,0,0] neg_hi:[1,0,0]
    v_pk_fma_f32 v[174:175], v[86:87], v[174:175], v[86:87] neg_lo:[1,0,0] neg_hi:[1,0,0]
    v_pk_fma_f32 v[176:177], v[88:89], v[176:177], v[88:89] neg_lo:[1,0,0] neg_hi:[1,0,0]
    v_pk_fma_f32 v[178:179], v[90:91], v[178:179], v[90:91] neg_lo:[1,0,0] neg_hi:[1,0,0]
    v_pk_fma_f32 v[180:181], v[92:93], v[180:181], v[92:93] neg_lo:[1,0,0] neg_hi:[1,0,0]
    v_pk_fma_f32 v[182:183], v[94:95], v[182:183], v[94:95] neg_lo:[1,0,0] neg_hi:[1,0,0]
    v_pk_fma_f32 v[184:185], v[96:97], v[184:185], v[96:97] neg_lo:[1,0,0] neg_hi:[1,0,0]
    v_pk_fma_f32 v[186:187], v[98:99], v[186:187], v[98:99] neg_lo:[1,0,0] neg_hi:[1,0,0]
    v_cvt_pk_bf16_f32 v84, v172, v173
    v_cvt_pk_bf16_f32 v85, v174, v175
    v_cvt_pk_bf16_f32 v86, v176, v177
    v_cvt_pk_bf16_f32 v87, v178, v179
    v_cvt_pk_bf16_f32 v88, v180, v181
    v_cvt_pk_bf16_f32 v89, v182, v183
    v_cvt_pk_bf16_f32 v90, v184, v185
    v_cvt_pk_bf16_f32 v91, v186, v187
    s_add_u32 s75, s75, 4096
    buffer_store_dwordx4 v[84:87], v1, s[40:43], s75 offen sc1
    buffer_store_dwordx4 v[88:91], v248, s[40:43], s75 offen sc1
    .p2align 3
    v_pk_fma_f32 v[156:157], v[234:235], v[116:117], v[124:125] op_sel_hi:[0,1,1] neg_lo:[1,0,0] neg_hi:[1,0,0]
    v_pk_fma_f32 v[158:159], v[234:235], v[118:119], v[126:127] op_sel_hi:[0,1,1] neg_lo:[1,0,0] neg_hi:[1,0,0]
    v_pk_fma_f32 v[160:161], v[234:235], v[120:121], v[128:129] op_sel_hi:[0,1,1] neg_lo:[1,0,0] neg_hi:[1,0,0]
    v_pk_fma_f32 v[162:163], v[234:235], v[122:123], v[130:131] op_sel_hi:[0,1,1] neg_lo:[1,0,0] neg_hi:[1,0,0]
    v_pk_fma_f32 v[164:165], v[236:237], v[116:117], v[124:125] op_sel_hi:[0,1,1] neg_lo:[1,0,0] neg_hi:[1,0,0]
    v_pk_fma_f32 v[166:167], v[236:237], v[118:119], v[126:127] op_sel_hi:[0,1,1] neg_lo:[1,0,0] neg_hi:[1,0,0]
    v_pk_fma_f32 v[168:169], v[236:237], v[120:121], v[128:129] op_sel_hi:[0,1,1] neg_lo:[1,0,0] neg_hi:[1,0,0]
    v_pk_fma_f32 v[170:171], v[236:237], v[122:123], v[130:131] op_sel_hi:[0,1,1] neg_lo:[1,0,0] neg_hi:[1,0,0]
    v_pk_fma_f32 v[100:101], v[100:101], v[10:11], v[156:157] op_sel_hi:[1,0,1]
    v_pk_fma_f32 v[102:103], v[102:103], v[10:11], v[158:159] op_sel_hi:[1,0,1]
    v_pk_fma_f32 v[104:105], v[104:105], v[10:11], v[160:161] op_sel_hi:[1,0,1]
    v_pk_fma_f32 v[106:107], v[106:107], v[10:11], v[162:163] op_sel_hi:[1,0,1]
    v_pk_fma_f32 v[108:109], v[108:109], v[12:13], v[164:165] op_sel_hi:[1,0,1]
    v_pk_fma_f32 v[110:111], v[110:111], v[12:13], v[166:167] op_sel_hi:[1,0,1]
    v_pk_fma_f32 v[112:113], v[112:113], v[12:13], v[168:169] op_sel_hi:[1,0,1]
    v_pk_fma_f32 v[114:115], v[114:115], v[12:13], v[170:171] op_sel_hi:[1,0,1]
    v_exp_f32 v172, v100
    v_exp_f32 v173, v101
    v_exp_f32 v174, v102
    v_exp_f32 v175, v103
    v_exp_f32 v176, v104
    v_exp_f32 v177, v105
    v_exp_f32 v178, v106
    v_exp_f32 v179, v107
    v_exp_f32 v180, v108
    v_exp_f32 v181, v109
    v_exp_f32 v182, v110
    v_exp_f32 v183, v111
    v_exp_f32 v184, v112
    v_exp_f32 v185, v113
    v_exp_f32 v186, v114
    v_exp_f32 v187, v115
    v_pk_fma_f32 v[156:157], v[172:173], v[220:221], v[226:227] op_sel_hi:[1,0,0]
    v_pk_fma_f32 v[158:159], v[174:175], v[220:221], v[226:227] op_sel_hi:[1,0,0]
    v_pk_fma_f32 v[160:161], v[176:177], v[220:221], v[226:227] op_sel_hi:[1,0,0]
    v_pk_fma_f32 v[162:163], v[178:179], v[220:221], v[226:227] op_sel_hi:[1,0,0]
    v_pk_fma_f32 v[164:165], v[180:181], v[220:221], v[226:227] op_sel_hi:[1,0,0]
    v_pk_fma_f32 v[166:167], v[182:183], v[220:221], v[226:227] op_sel_hi:[1,0,0]
    v_pk_fma_f32 v[168:169], v[184:185], v[220:221], v[226:227] op_sel_hi:[1,0,0]
    v_pk_fma_f32 v[170:171], v[186:187], v[220:221], v[226:227] op_sel_hi:[1,0,0]
    v_pk_fma_f32 v[172:173], v[172:173], v[156:157], v[226:227] op_sel_hi:[1,1,0]
    v_pk_fma_f32 v[174:175], v[174:175], v[158:159], v[226:227] op_sel_hi:[1,1,0]
    v_pk_fma_f32 v[176:177], v[176:177], v[160:161], v[226:227] op_sel_hi:[1,1,0]
    v_pk_fma_f32 v[178:179], v[178:179], v[162:163], v[226:227] op_sel_hi:[1,1,0]
    v_pk_fma_f32 v[180:181], v[180:181], v[164:165], v[226:227] op_sel_hi:[1,1,0]
    v_pk_fma_f32 v[182:183], v[182:183], v[166:167], v[226:227] op_sel_hi:[1,1,0]
    v_pk_fma_f32 v[184:185], v[184:185], v[168:169], v[226:227] op_sel_hi:[1,1,0]
    v_pk_fma_f32 v[186:187], v[186:187], v[170:171], v[226:227] op_sel_hi:[1,1,0]
    v_rcp_f32 v172, v172
    v_rcp_f32 v173, v173
    v_rcp_f32 v174, v174
    v_rcp_f32 v175, v175
    v_rcp_f32 v176, v176
    v_rcp_f32 v177, v177
    v_rcp_f32 v178, v178
    v_rcp_f32 v179, v179
    v_rcp_f32 v180, v180
    v_rcp_f32 v181, v181
    v_rcp_f32 v182, v182
    v_rcp_f32 v183, v183
    v_rcp_f32 v184, v184
    v_rcp_f32 v185, v185
    v_rcp_f32 v186, v186
    v_rcp_f32 v187, v187
    v_pk_fma_f32 v[172:173], v[100:101], v[172:173], v[100:101] neg_lo:[1,0,0] neg_hi:[1,0,0]
    v_pk_fma_f32 v[174:175], v[102:103], v[174:175], v[102:103] neg_lo:[1,0,0] neg_hi:[1,0,0]
    v_pk_fma_f32 v[176:177], v[104:105], v[176:177], v[104:105] neg_lo:[1,0,0] neg_hi:[1,0,0]
    v_pk_fma_f32 v[178:179], v[106:107], v[178:179], v[106:107] neg_lo:[1,0,0] neg_hi:[1,0,0]
    v_pk_fma_f32 v[180:181], v[108:109], v[180:181], v[108:109] neg_lo:[1,0,0] neg_hi:[1,0,0]
    v_pk_fma_f32 v[182:183], v[110:111], v[182:183], v[110:111] neg_lo:[1,0,0] neg_hi:[1,0,0]
    v_pk_fma_f32 v[184:185], v[112:113], v[184:185], v[112:113] neg_lo:[1,0,0] neg_hi:[1,0,0]
    v_pk_fma_f32 v[186:187], v[114:115], v[186:187], v[114:115] neg_lo:[1,0,0] neg_hi:[1,0,0]
    v_cvt_pk_bf16_f32 v100, v172, v173
    v_cvt_pk_bf16_f32 v101, v174, v175
    v_cvt_pk_bf16_f32 v102, v176, v177
    v_cvt_pk_bf16_f32 v103, v178, v179
    v_cvt_pk_bf16_f32 v104, v180, v181
    v_cvt_pk_bf16_f32 v105, v182, v183
    v_cvt_pk_bf16_f32 v106, v184, v185
    v_cvt_pk_bf16_f32 v107, v186, v187
    buffer_store_dwordx4 v[100:103], v16, s[40:43], s75 offen sc1
    buffer_store_dwordx4 v[104:107], v255, s[40:43], s75 offen sc1
L_mlp_short:
    s_waitcnt vmcnt(0)
    buffer_store_dword v241, v240, s[40:43], s64 offen sc1
    ds_write_b32 v14, v15 offset:64
    ds_write_b32 v14, v15 offset:112
    s_branch L_cdone
L_Catt:
    s_lshl1_add_u32 s77, s54, s53
    s_xor_b32 s78, s77, 1
    s_mul_i32 s79, s77, 3072
    s_add_u32 s79, s79, 147456
    v_add_u32 v249, s79, v1
    s_mul_i32 s79, s78, 3072
    s_add_u32 s79, s79, 147456
    v_add_u32 v250, s79, v1
    s_lshl1_add_u32 s77, s56, s54
    s_lshl_b32 s65, s77, 15
    s_lshl_b32 s77, s53, 10
    s_add_u32 s65, s65, s77
    s_add_u32 s65, s65, 393216
    s_mov_b32 s86, 0x55555555
    s_mov_b32 s87, 0x55555555
    s_sub_u32 s66, 0, s53
    s_mov_b32 s67, s66
    s_lshl_b32 s70, s55, 11
    s_add_u32 s70, s70, s65
    s_lshl1_add_u32 s71, s56, s54
    s_lshl_b32 s71, s71, 10
    s_add_u32 s71, s71, 45056
    s_add_u32 s71, s71, s75
    v_and_b32 v253, 15, v0
    v_lshlrev_b32 v253, 11, v253
    v_and_b32 v254, 3, v0
    v_lshlrev_b32 v254, 2, v254
    v_add_u32 v254, 162304, v254
    s_waitcnt lgkmcnt(0)
    s_barrier
    ds_read_b128 v[116:119], v2 offset:0
    ds_read_b64_tr_b16 v[132:133], v4 offset:0
    ds_read_b64_tr_b16 v[134:135], v4 offset:512
    ds_read_b128 v[120:123], v2 offset:2048
    ds_read_b128 v[124:127], v2 offset:4096
    ds_read_b128 v[128:131], v2 offset:6144
    ds_read_b64_tr_b16 v[136:137], v5 offset:0
    ds_read_b64_tr_b16 v[138:139], v5 offset:512
    ds_read_b64_tr_b16 v[140:141], v4 offset:1024
    ds_read_b64_tr_b16 v[142:143], v4 offset:1536
    ds_read_b64_tr_b16 v[144:145], v5 offset:1024
    ds_read_b64_tr_b16 v[146:147], v5 offset:1536
    ds_read_b64_tr_b16 v[148:149], v4 offset:2048
    ds_read_b64_tr_b16 v[150:151], v4 offset:2560
    ds_read_b64_tr_b16 v[152:153], v5 offset:2048
    ds_read_b64_tr_b16 v[154:155], v5 offset:2560
    s_waitcnt lgkmcnt(13)
    v_mfma_f32_16x16x32_bf16 v[20:23], v[132:135], v[116:119], 0
    ds_read_b128 v[156:159], v3 offset:0
    s_waitcnt lgkmcnt(11)
    v_mfma_f32_16x16x32_bf16 v[28:31], v[132:135], v[120:123], 0
    ds_read_b64_tr_b16 v[172:173], v4 offset:12288
    v_mfma_f32_16x16x32_bf16 v[36:39], v[132:135], v[124:127], 0
    ds_read_b64_tr_b16 v[174:175], v4 offset:12800
    v_mfma_f32_16x16x32_bf16 v[44:47], v[132:135], v[128:131], 0
    ds_read_b128 v[160:163], v3 offset:2048
    s_waitcnt lgkmcnt(12)
    v_mfma_f32_16x16x32_bf16 v[48:51], v[136:139], v[128:131], 0
    ds_read_b128 v[164:167], v3 offset:4096
    v_mfma_f32_16x16x32_bf16 v[40:43], v[136:139], v[124:127], 0
    ds_read_b128 v[168:171], v3 offset:6144
    v_mfma_f32_16x16x32_bf16 v[32:35], v[136:139], v[120:123], 0
    ds_read_b64_tr_b16 v[176:177], v5 offset:12288
    v_mfma_f32_16x16x32_bf16 v[24:27], v[136:139], v[116:119], 0
    ds_read_b64_tr_b16 v[178:179], v5 offset:12800
    s_waitcnt lgkmcnt(14)
    v_mfma_f32_16x16x32_bf16 v[52:55], v[116:119], v[140:143], 0
    ds_read_b64_tr_b16 v[180:181], v4 offset:13312
    v_mfma_f32_16x16x32_bf16 v[60:63], v[120:123], v[140:143], 0
    ds_read_b64_tr_b16 v[182:183], v4 offset:13824
    v_mfma_f32_16x16x32_bf16 v[68:71], v[124:127], v[140:143], 0
    ds_read_b64_tr_b16 v[184:185], v5 offset:13312
    v_mfma_f32_16x16x32_bf16 v[76:79], v[128:131], v[140:143], 0
    ds_read_b64_tr_b16 v[186:187], v5 offset:13824
    s_waitcnt lgkmcnt(15)
    v_mfma_f32_16x16x32_bf16 v[80:83], v[128:131], v[144:147], 0
    ds_read_b64_tr_b16 v[188:189], v4 offset:14336
    v_mfma_f32_16x16x32_bf16 v[72:75], v[124:127], v[144:147], 0
    ds_read_b64_tr_b16 v[190:191], v4 offset:14848
    v_mfma_f32_16x16x32_bf16 v[64:67], v[120:123], v[144:147], 0
    ds_read_b64_tr_b16 v[192:193], v5 offset:14336
    v_mfma_f32_16x16x32_bf16 v[56:59], v[116:119], v[144:147], 0
    ds_read_b64_tr_b16 v[194:195], v5 offset:14848
    s_waitcnt lgkmcnt(15)
    v_mfma_f32_16x16x32_bf16 v[84:87], v[116:119], v[148:151], 0
    v_mfma_f32_16x16x32_bf16 v[92:95], v[120:123], v[148:151], 0
    v_mfma_f32_16x16x32_bf16 v[100:103], v[124:127], v[148:151], 0
    v_mfma_f32_16x16x32_bf16 v[108:111], v[128:131], v[148:151], 0
    s_waitcnt lgkmcnt(15)
    v_mfma_f32_16x16x32_bf16 v[112:115], v[128:131], v[152:155], 0
    v_mfma_f32_16x16x32_bf16 v[104:107], v[124:127], v[152:155], 0
    v_mfma_f32_16x16x32_bf16 v[96:99], v[120:123], v[152:155], 0
    v_mfma_f32_16x16x32_bf16 v[88:91], v[116:119], v[152:155], 0
    s_waitcnt lgkmcnt(0)
    s_barrier
    v_mfma_f32_16x16x32_bf16 v[20:23], v[172:175], v[156:159], v[20:23]
    ds_read_b128 v[116:119], v2 offset:16384
    v_mfma_f32_16x16x32_bf16 v[28:31], v[172:175], v[160:163], v[28:31]
    ds_read_b64_tr_b16 v[132:133], v4 offset:24576
    v_mfma_f32_16x16x32_bf16 v[36:39], v[172:175], v[164:167], v[36:39]
    ds_read_b64_tr_b16 v[134:135], v4 offset:25088
    v_mfma_f32_16x16x32_bf16 v[44:47], v[172:175], v[168:171], v[44:47]
    ds_read_b128 v[120:123], v2 offset:18432
    v_mfma_f32_16x16x32_bf16 v[48:51], v[176:179], v[168:171], v[48:51]
    ds_read_b128 v[124:127], v2 offset:20480
    v_mfma_f32_16x16x32_bf16 v[40:43], v[176:179], v[164:167], v[40:43]
    ds_read_b128 v[128:131], v2 offset:22528
    v_mfma_f32_16x16x32_bf16 v[32:35], v[176:179], v[160:163], v[32:35]
    ds_read_b64_tr_b16 v[136:137], v5 offset:24576
    v_mfma_f32_16x16x32_bf16 v[24:27], v[176:179], v[156:159], v[24:27]
    ds_read_b64_tr_b16 v[138:139], v5 offset:25088
    v_mfma_f32_16x16x32_bf16 v[52:55], v[156:159], v[180:183], v[52:55]
    ds_read_b64_tr_b16 v[140:141], v4 offset:25600
    v_mfma_f32_16x16x32_bf16 v[60:63], v[160:163], v[180:183], v[60:63]
    ds_read_b64_tr_b16 v[142:143], v4 offset:26112
    v_mfma_f32_16x16x32_bf16 v[68:71], v[164:167], v[180:183], v[68:71]
    ds_read_b64_tr_b16 v[144:145], v5 offset:25600
    v_mfma_f32_16x16x32_bf16 v[76:79], v[168:171], v[180:183], v[76:79]
    ds_read_b64_tr_b16 v[146:147], v5 offset:26112
    v_mfma_f32_16x16x32_bf16 v[80:83], v[168:171], v[184:187], v[80:83]
    ds_read_b64_tr_b16 v[148:149], v4 offset:26624
    v_mfma_f32_16x16x32_bf16 v[72:75], v[164:167], v[184:187], v[72:75]
    ds_read_b64_tr_b16 v[150:151], v4 offset:27136
    v_mfma_f32_16x16x32_bf16 v[64:67], v[160:163], v[184:187], v[64:67]
    ds_read_b64_tr_b16 v[152:153], v5 offset:26624
    v_mfma_f32_16x16x32_bf16 v[56:59], v[156:159], v[184:187], v[56:59]
    ds_read_b64_tr_b16 v[154:155], v5 offset:27136
    v_mfma_f32_16x16x32_bf16 v[84:87], v[156:159], v[188:191], v[84:87]
    v_mfma_f32_16x16x32_bf16 v[92:95], v[160:163], v[188:191], v[92:95]
    v_mfma_f32_16x16x32_bf16 v[100:103], v[164:167], v[188:191], v[100:103]
    v_mfma_f32_16x16x32_bf16 v[108:111], v[168:171], v[188:191], v[108:111]
    v_mfma_f32_16x16x32_bf16 v[112:115], v[168:171], v[192:195], v[112:115]
    v_mfma_f32_16x16x32_bf16 v[104:107], v[164:167], v[192:195], v[104:107]
    v_mfma_f32_16x16x32_bf16 v[96:99], v[160:163], v[192:195], v[96:99]
    v_mfma_f32_16x16x32_bf16 v[88:91], v[156:159], v[192:195], v[88:91]
    s_waitcnt lgkmcnt(13)
    v_mfma_f32_16x16x32_bf16 v[20:23], v[132:135], v[116:119], v[20:23]
    ds_read_b128 v[156:159], v3 offset:16384
    s_waitcnt lgkmcnt(11)
    v_mfma_f32_16x16x32_bf16 v[28:31], v[132:135], v[120:123], v[28:31]
    ds_read_b64_tr_b16 v[172:173], v4 offset:36864
    v_mfma_f32_16x16x32_bf16 v[36:39], v[132:135], v[124:127], v[36:39]
    ds_read_b64_tr_b16 v[174:175], v4 offset:37376
    v_mfma_f32_16x16x32_bf16 v[44:47], v[132:135], v[128:131], v[44:47]
    ds_read_b128 v[160:163], v3 offset:18432
    s_waitcnt lgkmcnt(12)
    v_mfma_f32_16x16x32_bf16 v[48:51], v[136:139], v[128:131], v[48:51]
    ds_read_b128 v[164:167], v3 offset:20480
    v_mfma_f32_16x16x32_bf16 v[40:43], v[136:139], v[124:127], v[40:43]
    ds_read_b128 v[168:171], v3 offset:22528
    v_mfma_f32_16x16x32_bf16 v[32:35], v[136:139], v[120:123], v[32:35]
    ds_read_b64_tr_b16 v[176:177], v5 offset:36864
    v_mfma_f32_16x16x32_bf16 v[24:27], v[136:139], v[116:119], v[24:27]
    ds_read_b64_tr_b16 v[178:179], v5 offset:37376
    s_waitcnt lgkmcnt(14)
    v_mfma_f32_16x16x32_bf16 v[52:55], v[116:119], v[140:143], v[52:55]
    ds_read_b64_tr_b16 v[180:181], v4 offset:37888
    v_mfma_f32_16x16x32_bf16 v[60:63], v[120:123], v[140:143], v[60:63]
    ds_read_b64_tr_b16 v[182:183], v4 offset:38400
    v_mfma_f32_16x16x32_bf16 v[68:71], v[124:127], v[140:143], v[68:71]
    ds_read_b64_tr_b16 v[184:185], v5 offset:37888
    v_mfma_f32_16x16x32_bf16 v[76:79], v[128:131], v[140:143], v[76:79]
    ds_read_b64_tr_b16 v[186:187], v5 offset:38400
    s_waitcnt lgkmcnt(15)
    v_mfma_f32_16x16x32_bf16 v[80:83], v[128:131], v[144:147], v[80:83]
    ds_read_b64_tr_b16 v[188:189], v4 offset:38912
    v_mfma_f32_16x16x32_bf16 v[72:75], v[124:127], v[144:147], v[72:75]
    ds_read_b64_tr_b16 v[190:191], v4 offset:39424
    v_mfma_f32_16x16x32_bf16 v[64:67], v[120:123], v[144:147], v[64:67]
    ds_read_b64_tr_b16 v[192:193], v5 offset:38912
    v_mfma_f32_16x16x32_bf16 v[56:59], v[116:119], v[144:147], v[56:59]
    ds_read_b64_tr_b16 v[194:195], v5 offset:39424
    s_waitcnt lgkmcnt(15)
    v_mfma_f32_16x16x32_bf16 v[84:87], v[116:119], v[148:151], v[84:87]
    v_mfma_f32_16x16x32_bf16 v[92:95], v[120:123], v[148:151], v[92:95]
    v_mfma_f32_16x16x32_bf16 v[100:103], v[124:127], v[148:151], v[100:103]
    v_mfma_f32_16x16x32_bf16 v[108:111], v[128:131], v[148:151], v[108:111]
    s_waitcnt lgkmcnt(15)
    v_mfma_f32_16x16x32_bf16 v[112:115], v[128:131], v[152:155], v[112:115]
    v_mfma_f32_16x16x32_bf16 v[104:107], v[124:127], v[152:155], v[104:107]
    v_mfma_f32_16x16x32_bf16 v[96:99], v[120:123], v[152:155], v[96:99]
    v_mfma_f32_16x16x32_bf16 v[88:91], v[116:119], v[152:155], v[88:91]
    s_waitcnt lgkmcnt(0)
    s_barrier
    v_mfma_f32_16x16x32_bf16 v[20:23], v[172:175], v[156:159], v[20:23]
    ds_read_b128 v[116:119], v2 offset:32768
    v_mfma_f32_16x16x32_bf16 v[28:31], v[172:175], v[160:163], v[28:31]
    ds_read_b64_tr_b16 v[132:133], v4 offset:49152
    v_mfma_f32_16x16x32_bf16 v[36:39], v[172:175], v[164:167], v[36:39]
    ds_read_b64_tr_b16 v[134:135], v4 offset:49664
    v_mfma_f32_16x16x32_bf16 v[44:47], v[172:175], v[168:171], v[44:47]
    ds_read_b128 v[120:123], v2 offset:34816
    v_mfma_f32_16x16x32_bf16 v[48:51], v[176:179], v[168:171], v[48:51]
    ds_read_b128 v[124:127], v2 offset:36864
    v_mfma_f32_16x16x32_bf16 v[40:43], v[176:179], v[164:167], v[40:43]
    ds_read_b128 v[128:131], v2 offset:38912
    v_mfma_f32_16x16x32_bf16 v[32:35], v[176:179], v[160:163], v[32:35]
    ds_read_b64_tr_b16 v[136:137], v5 offset:49152
    v_mfma_f32_16x16x32_bf16 v[24:27], v[176:179], v[156:159], v[24:27]
    ds_read_b64_tr_b16 v[138:139], v5 offset:49664
    v_mfma_f32_16x16x32_bf16 v[52:55], v[156:159], v[180:183], v[52:55]
    ds_read_b64_tr_b16 v[140:141], v4 offset:50176
    v_mfma_f32_16x16x32_bf16 v[60:63], v[160:163], v[180:183], v[60:63]
    ds_read_b64_tr_b16 v[142:143], v4 offset:50688
    v_mfma_f32_16x16x32_bf16 v[68:71], v[164:167], v[180:183], v[68:71]
    ds_read_b64_tr_b16 v[144:145], v5 offset:50176
    v_mfma_f32_16x16x32_bf16 v[76:79], v[168:171], v[180:183], v[76:79]
    ds_read_b64_tr_b16 v[146:147], v5 offset:50688
    v_mfma_f32_16x16x32_bf16 v[80:83], v[168:171], v[184:187], v[80:83]
    ds_read_b64_tr_b16 v[148:149], v4 offset:51200
    v_mfma_f32_16x16x32_bf16 v[72:75], v[164:167], v[184:187], v[72:75]
    ds_read_b64_tr_b16 v[150:151], v4 offset:51712
    v_mfma_f32_16x16x32_bf16 v[64:67], v[160:163], v[184:187], v[64:67]
    ds_read_b64_tr_b16 v[152:153], v5 offset:51200
    v_mfma_f32_16x16x32_bf16 v[56:59], v[156:159], v[184:187], v[56:59]
    ds_read_b64_tr_b16 v[154:155], v5 offset:51712
    v_mfma_f32_16x16x32_bf16 v[84:87], v[156:159], v[188:191], v[84:87]
    v_mfma_f32_16x16x32_bf16 v[92:95], v[160:163], v[188:191], v[92:95]
    v_mfma_f32_16x16x32_bf16 v[100:103], v[164:167], v[188:191], v[100:103]
    v_mfma_f32_16x16x32_bf16 v[108:111], v[168:171], v[188:191], v[108:111]
    v_mfma_f32_16x16x32_bf16 v[112:115], v[168:171], v[192:195], v[112:115]
    v_mfma_f32_16x16x32_bf16 v[104:107], v[164:167], v[192:195], v[104:107]
    v_mfma_f32_16x16x32_bf16 v[96:99], v[160:163], v[192:195], v[96:99]
    v_mfma_f32_16x16x32_bf16 v[88:91], v[156:159], v[192:195], v[88:91]
    s_waitcnt lgkmcnt(13)
    v_mfma_f32_16x16x32_bf16 v[20:23], v[132:135], v[116:119], v[20:23]
    ds_read_b128 v[156:159], v3 offset:32768
    s_waitcnt lgkmcnt(11)
    v_mfma_f32_16x16x32_bf16 v[28:31], v[132:135], v[120:123], v[28:31]
    ds_read_b64_tr_b16 v[172:173], v4 offset:61440
    v_mfma_f32_16x16x32_bf16 v[36:39], v[132:135], v[124:127], v[36:39]
    ds_read_b64_tr_b16 v[174:175], v4 offset:61952
    v_mfma_f32_16x16x32_bf16 v[44:47], v[132:135], v[128:131], v[44:47]
    ds_read_b128 v[160:163], v3 offset:34816
    s_waitcnt lgkmcnt(12)
    v_mfma_f32_16x16x32_bf16 v[48:51], v[136:139], v[128:131], v[48:51]
    ds_read_b128 v[164:167], v3 offset:36864
    v_mfma_f32_16x16x32_bf16 v[40:43], v[136:139], v[124:127], v[40:43]
    ds_read_b128 v[168:171], v3 offset:38912
    v_mfma_f32_16x16x32_bf16 v[32:35], v[136:139], v[120:123], v[32:35]
    ds_read_b64_tr_b16 v[176:177], v5 offset:61440
    v_mfma_f32_16x16x32_bf16 v[24:27], v[136:139], v[116:119], v[24:27]
    ds_read_b64_tr_b16 v[178:179], v5 offset:61952
    s_waitcnt lgkmcnt(14)
    v_mfma_f32_16x16x32_bf16 v[52:55], v[116:119], v[140:143], v[52:55]
    ds_read_b64_tr_b16 v[180:181], v4 offset:62464
    v_mfma_f32_16x16x32_bf16 v[60:63], v[120:123], v[140:143], v[60:63]
    ds_read_b64_tr_b16 v[182:183], v4 offset:62976
    v_mfma_f32_16x16x32_bf16 v[68:71], v[124:127], v[140:143], v[68:71]
    ds_read_b64_tr_b16 v[184:185], v5 offset:62464
    v_mfma_f32_16x16x32_bf16 v[76:79], v[128:131], v[140:143], v[76:79]
    ds_read_b64_tr_b16 v[186:187], v5 offset:62976
    s_waitcnt lgkmcnt(15)
    v_mfma_f32_16x16x32_bf16 v[80:83], v[128:131], v[144:147], v[80:83]
    ds_read_b64_tr_b16 v[188:189], v4 offset:63488
    v_mfma_f32_16x16x32_bf16 v[72:75], v[124:127], v[144:147], v[72:75]
    ds_read_b64_tr_b16 v[190:191], v4 offset:64000
    v_mfma_f32_16x16x32_bf16 v[64:67], v[120:123], v[144:147], v[64:67]
    ds_read_b64_tr_b16 v[192:193], v5 offset:63488
    v_mfma_f32_16x16x32_bf16 v[56:59], v[116:119], v[144:147], v[56:59]
    ds_read_b64_tr_b16 v[194:195], v5 offset:64000
    s_waitcnt lgkmcnt(15)
    v_mfma_f32_16x16x32_bf16 v[84:87], v[116:119], v[148:151], v[84:87]
    v_mfma_f32_16x16x32_bf16 v[92:95], v[120:123], v[148:151], v[92:95]
    v_mfma_f32_16x16x32_bf16 v[100:103], v[124:127], v[148:151], v[100:103]
    v_mfma_f32_16x16x32_bf16 v[108:111], v[128:131], v[148:151], v[108:111]
    s_waitcnt lgkmcnt(15)
    v_mfma_f32_16x16x32_bf16 v[112:115], v[128:131], v[152:155], v[112:115]
    v_mfma_f32_16x16x32_bf16 v[104:107], v[124:127], v[152:155], v[104:107]
    v_mfma_f32_16x16x32_bf16 v[96:99], v[120:123], v[152:155], v[96:99]
    v_mfma_f32_16x16x32_bf16 v[88:91], v[116:119], v[152:155], v[88:91]
    s_waitcnt lgkmcnt(0)
    s_barrier
    v_mfma_f32_16x16x32_bf16 v[20:23], v[172:175], v[156:159], v[20:23]
    ds_read_b128 v[116:119], v2 offset:0
    v_mfma_f32_16x16x32_bf16 v[28:31], v[172:175], v[160:163], v[28:31]
    ds_read_b64_tr_b16 v[132:133], v4 offset:0
    v_mfma_f32_16x16x32_bf16 v[36:39], v[172:175], v[164:167], v[36:39]
    ds_read_b64_tr_b16 v[134:135], v4 offset:512
    v_mfma_f32_16x16x32_bf16 v[44:47], v[172:175], v[168:171], v[44:47]
    ds_read_b128 v[120:123], v2 offset:2048
    v_mfma_f32_16x16x32_bf16 v[48:51], v[176:179], v[168:171], v[48:51]
    ds_read_b128 v[124:127], v2 offset:4096
    v_mfma_f32_16x16x32_bf16 v[40:43], v[176:179], v[164:167], v[40:43]
    ds_read_b128 v[128:131], v2 offset:6144
    v_mfma_f32_16x16x32_bf16 v[32:35], v[176:179], v[160:163], v[32:35]
    ds_read_b64_tr_b16 v[136:137], v5 offset:0
    v_mfma_f32_16x16x32_bf16 v[24:27], v[176:179], v[156:159], v[24:27]
    ds_read_b64_tr_b16 v[138:139], v5 offset:512
    v_mfma_f32_16x16x32_bf16 v[52:55], v[156:159], v[180:183], v[52:55]
    ds_read_b64_tr_b16 v[140:141], v4 offset:1024
    v_mfma_f32_16x16x32_bf16 v[60:63], v[160:163], v[180:183], v[60:63]
    ds_read_b64_tr_b16 v[142:143], v4 offset:1536
    v_mfma_f32_16x16x32_bf16 v[68:71], v[164:167], v[180:183], v[68:71]
    ds_read_b64_tr_b16 v[144:145], v5 offset:1024
    v_mfma_f32_16x16x32_bf16 v[76:79], v[168:171], v[180:183], v[76:79]
    ds_read_b64_tr_b16 v[146:147], v5 offset:1536
    v_mfma_f32_16x16x32_bf16 v[80:83], v[168:171], v[184:187], v[80:83]
    ds_read_b64_tr_b16 v[148:149], v4 offset:2048
    v_mfma_f32_16x16x32_bf16 v[72:75], v[164:167], v[184:187], v[72:75]
    ds_read_b64_tr_b16 v[150:151], v4 offset:2560
    v_mfma_f32_16x16x32_bf16 v[64:67], v[160:163], v[184:187], v[64:67]
    ds_read_b64_tr_b16 v[152:153], v5 offset:2048
    v_mfma_f32_16x16x32_bf16 v[56:59], v[156:159], v[184:187], v[56:59]
    ds_read_b64_tr_b16 v[154:155], v5 offset:2560
    v_mfma_f32_16x16x32_bf16 v[84:87], v[156:159], v[188:191], v[84:87]
    v_mfma_f32_16x16x32_bf16 v[92:95], v[160:163], v[188:191], v[92:95]
    v_mfma_f32_16x16x32_bf16 v[100:103], v[164:167], v[188:191], v[100:103]
    v_mfma_f32_16x16x32_bf16 v[108:111], v[168:171], v[188:191], v[108:111]
    v_mfma_f32_16x16x32_bf16 v[112:115], v[168:171], v[192:195], v[112:115]
    v_mfma_f32_16x16x32_bf16 v[104:107], v[164:167], v[192:195], v[104:107]
    v_mfma_f32_16x16x32_bf16 v[96:99], v[160:163], v[192:195], v[96:99]
    v_mfma_f32_16x16x32_bf16 v[88:91], v[156:159], v[192:195], v[88:91]
    s_waitcnt lgkmcnt(13)
    v_mfma_f32_16x16x32_bf16 v[20:23], v[132:135], v[116:119], v[20:23]
    ds_read_b128 v[156:159], v3 offset:0
    s_waitcnt lgkmcnt(11)
    v_mfma_f32_16x16x32_bf16 v[28:31], v[132:135], v[120:123], v[28:31]
    ds_read_b64_tr_b16 v[172:173], v4 offset:12288
    v_mfma_f32_16x16x32_bf16 v[36:39], v[132:135], v[124:127], v[36:39]
    ds_read_b64_tr_b16 v[174:175], v4 offset:12800
    v_mfma_f32_16x16x32_bf16 v[44:47], v[132:135], v[128:131], v[44:47]
    ds_read_b128 v[160:163], v3 offset:2048
    s_waitcnt lgkmcnt(12)
    v_mfma_f32_16x16x32_bf16 v[48:51], v[136:139], v[128:131], v[48:51]
    ds_read_b128 v[164:167], v3 offset:4096
    v_mfma_f32_16x16x32_bf16 v[40:43], v[136:139], v[124:127], v[40:43]
    ds_read_b128 v[168:171], v3 offset:6144
    v_mfma_f32_16x16x32_bf16 v[32:35], v[136:139], v[120:123], v[32:35]
    ds_read_b64_tr_b16 v[176:177], v5 offset:12288
    v_mfma_f32_16x16x32_bf16 v[24:27], v[136:139], v[116:119], v[24:27]
    ds_read_b64_tr_b16 v[178:179], v5 offset:12800
    s_waitcnt lgkmcnt(14)
    v_mfma_f32_16x16x32_bf16 v[52:55], v[116:119], v[140:143], v[52:55]
    ds_read_b64_tr_b16 v[180:181], v4 offset:13312
    v_mfma_f32_16x16x32_bf16 v[60:63], v[120:123], v[140:143], v[60:63]
    ds_read_b64_tr_b16 v[182:183], v4 offset:13824
    v_mfma_f32_16x16x32_bf16 v[68:71], v[124:127], v[140:143], v[68:71]
    ds_read_b64_tr_b16 v[184:185], v5 offset:13312
    v_mfma_f32_16x16x32_bf16 v[76:79], v[128:131], v[140:143], v[76:79]
    ds_read_b64_tr_b16 v[186:187], v5 offset:13824
    s_waitcnt lgkmcnt(15)
    v_mfma_f32_16x16x32_bf16 v[80:83], v[128:131], v[144:147], v[80:83]
    ds_read_b64_tr_b16 v[188:189], v4 offset:14336
    v_mfma_f32_16x16x32_bf16 v[72:75], v[124:127], v[144:147], v[72:75]
    ds_read_b64_tr_b16 v[190:191], v4 offset:14848
    v_mfma_f32_16x16x32_bf16 v[64:67], v[120:123], v[144:147], v[64:67]
    ds_read_b64_tr_b16 v[192:193], v5 offset:14336
    v_mfma_f32_16x16x32_bf16 v[56:59], v[116:119], v[144:147], v[56:59]
    ds_read_b64_tr_b16 v[194:195], v5 offset:14848
    s_waitcnt lgkmcnt(15)
    v_mfma_f32_16x16x32_bf16 v[84:87], v[116:119], v[148:151], v[84:87]
    v_mfma_f32_16x16x32_bf16 v[92:95], v[120:123], v[148:151], v[92:95]
    v_mfma_f32_16x16x32_bf16 v[100:103], v[124:127], v[148:151], v[100:103]
    v_mfma_f32_16x16x32_bf16 v[108:111], v[128:131], v[148:151], v[108:111]
    s_waitcnt lgkmcnt(15)
    v_mfma_f32_16x16x32_bf16 v[112:115], v[128:131], v[152:155], v[112:115]
    v_mfma_f32_16x16x32_bf16 v[104:107], v[124:127], v[152:155], v[104:107]
    v_mfma_f32_16x16x32_bf16 v[96:99], v[120:123], v[152:155], v[96:99]
    v_mfma_f32_16x16x32_bf16 v[88:91], v[116:119], v[152:155], v[88:91]
    s_waitcnt lgkmcnt(0)
    s_barrier
    v_mfma_f32_16x16x32_bf16 v[20:23], v[172:175], v[156:159], v[20:23]
    ds_read_b128 v[116:119], v2 offset:16384
    v_mfma_f32_16x16x32_bf16 v[28:31], v[172:175], v[160:163], v[28:31]
    ds_read_b64_tr_b16 v[132:133], v4 offset:24576
    v_mfma_f32_16x16x32_bf16 v[36:39], v[172:175], v[164:167], v[36:39]
    ds_read_b64_tr_b16 v[134:135], v4 offset:25088
    v_mfma_f32_16x16x32_bf16 v[44:47], v[172:175], v[168:171], v[44:47]
    ds_read_b128 v[120:123], v2 offset:18432
    v_mfma_f32_16x16x32_bf16 v[48:51], v[176:179], v[168:171], v[48:51]
    ds_read_b128 v[124:127], v2 offset:20480
    v_mfma_f32_16x16x32_bf16 v[40:43], v[176:179], v[164:167], v[40:43]
    ds_read_b128 v[128:131], v2 offset:22528
    v_mfma_f32_16x16x32_bf16 v[32:35], v[176:179], v[160:163], v[32:35]
    ds_read_b64_tr_b16 v[136:137], v5 offset:24576
    v_mfma_f32_16x16x32_bf16 v[24:27], v[176:179], v[156:159], v[24:27]
    ds_read_b64_tr_b16 v[138:139], v5 offset:25088
    v_mfma_f32_16x16x32_bf16 v[52:55], v[156:159], v[180:183], v[52:55]
    ds_read_b64_tr_b16 v[140:141], v4 offset:25600
    v_mfma_f32_16x16x32_bf16 v[60:63], v[160:163], v[180:183], v[60:63]
    ds_read_b64_tr_b16 v[142:143], v4 offset:26112
    v_mfma_f32_16x16x32_bf16 v[68:71], v[164:167], v[180:183], v[68:71]
    ds_read_b64_tr_b16 v[144:145], v5 offset:25600
    v_mfma_f32_16x16x32_bf16 v[76:79], v[168:171], v[180:183], v[76:79]
    ds_read_b64_tr_b16 v[146:147], v5 offset:26112
    v_mfma_f32_16x16x32_bf16 v[80:83], v[168:171], v[184:187], v[80:83]
    ds_read_b64_tr_b16 v[148:149], v4 offset:26624
    v_mfma_f32_16x16x32_bf16 v[72:75], v[164:167], v[184:187], v[72:75]
    ds_read_b64_tr_b16 v[150:151], v4 offset:27136
    v_mfma_f32_16x16x32_bf16 v[64:67], v[160:163], v[184:187], v[64:67]
    ds_read_b64_tr_b16 v[152:153], v5 offset:26624
    v_mfma_f32_16x16x32_bf16 v[56:59], v[156:159], v[184:187], v[56:59]
    ds_read_b64_tr_b16 v[154:155], v5 offset:27136
    v_mfma_f32_16x16x32_bf16 v[84:87], v[156:159], v[188:191], v[84:87]
    v_mfma_f32_16x16x32_bf16 v[92:95], v[160:163], v[188:191], v[92:95]
    v_mfma_f32_16x16x32_bf16 v[100:103], v[164:167], v[188:191], v[100:103]
    v_mfma_f32_16x16x32_bf16 v[108:111], v[168:171], v[188:191], v[108:111]
    v_mfma_f32_16x16x32_bf16 v[112:115], v[168:171], v[192:195], v[112:115]
    v_mfma_f32_16x16x32_bf16 v[104:107], v[164:167], v[192:195], v[104:107]
    v_mfma_f32_16x16x32_bf16 v[96:99], v[160:163], v[192:195], v[96:99]
    v_mfma_f32_16x16x32_bf16 v[88:91], v[156:159], v[192:195], v[88:91]
    s_waitcnt lgkmcnt(13)
    v_mfma_f32_16x16x32_bf16 v[20:23], v[132:135], v[116:119], v[20:23]
    ds_read_b128 v[156:159], v3 offset:16384
    s_waitcnt lgkmcnt(11)
    v_mfma_f32_16x16x32_bf16 v[28:31], v[132:135], v[120:123], v[28:31]
    ds_read_b64_tr_b16 v[172:173], v4 offset:36864
    v_mfma_f32_16x16x32_bf16 v[36:39], v[132:135], v[124:127], v[36:39]
    ds_read_b64_tr_b16 v[174:175], v4 offset:37376
    v_mfma_f32_16x16x32_bf16 v[44:47], v[132:135], v[128:131], v[44:47]
    ds_read_b128 v[160:163], v3 offset:18432
    s_waitcnt lgkmcnt(12)
    v_mfma_f32_16x16x32_bf16 v[48:51], v[136:139], v[128:131], v[48:51]
    ds_read_b128 v[164:167], v3 offset:20480
    v_mfma_f32_16x16x32_bf16 v[40:43], v[136:139], v[124:127], v[40:43]
    ds_read_b128 v[168:171], v3 offset:22528
    v_mfma_f32_16x16x32_bf16 v[32:35], v[136:139], v[120:123], v[32:35]
    ds_read_b64_tr_b16 v[176:177], v5 offset:36864
    v_mfma_f32_16x16x32_bf16 v[24:27], v[136:139], v[116:119], v[24:27]
    ds_read_b64_tr_b16 v[178:179], v5 offset:37376
    s_waitcnt lgkmcnt(14)
    v_mfma_f32_16x16x32_bf16 v[52:55], v[116:119], v[140:143], v[52:55]
    ds_read_b64_tr_b16 v[180:181], v4 offset:37888
    v_mfma_f32_16x16x32_bf16 v[60:63], v[120:123], v[140:143], v[60:63]
    ds_read_b64_tr_b16 v[182:183], v4 offset:38400
    v_mfma_f32_16x16x32_bf16 v[68:71], v[124:127], v[140:143], v[68:71]
    ds_read_b64_tr_b16 v[184:185], v5 offset:37888
    v_mfma_f32_16x16x32_bf16 v[76:79], v[128:131], v[140:143], v[76:79]
    ds_read_b64_tr_b16 v[186:187], v5 offset:38400
    s_waitcnt lgkmcnt(15)
    v_mfma_f32_16x16x32_bf16 v[80:83], v[128:131], v[144:147], v[80:83]
    ds_read_b64_tr_b16 v[188:189], v4 offset:38912
    v_mfma_f32_16x16x32_bf16 v[72:75], v[124:127], v[144:147], v[72:75]
    ds_read_b64_tr_b16 v[190:191], v4 offset:39424
    v_mfma_f32_16x16x32_bf16 v[64:67], v[120:123], v[144:147], v[64:67]
    ds_read_b64_tr_b16 v[192:193], v5 offset:38912
    v_mfma_f32_16x16x32_bf16 v[56:59], v[116:119], v[144:147], v[56:59]
    ds_read_b64_tr_b16 v[194:195], v5 offset:39424
    s_waitcnt lgkmcnt(15)
    v_mfma_f32_16x16x32_bf16 v[84:87], v[116:119], v[148:151], v[84:87]
    v_mfma_f32_16x16x32_bf16 v[92:95], v[120:123], v[148:151], v[92:95]
    v_mfma_f32_16x16x32_bf16 v[100:103], v[124:127], v[148:151], v[100:103]
    v_mfma_f32_16x16x32_bf16 v[108:111], v[128:131], v[148:151], v[108:111]
    s_waitcnt lgkmcnt(15)
    v_mfma_f32_16x16x32_bf16 v[112:115], v[128:131], v[152:155], v[112:115]
    v_mfma_f32_16x16x32_bf16 v[104:107], v[124:127], v[152:155], v[104:107]
    v_mfma_f32_16x16x32_bf16 v[96:99], v[120:123], v[152:155], v[96:99]
    v_mfma_f32_16x16x32_bf16 v[88:91], v[116:119], v[152:155], v[88:91]
    s_waitcnt lgkmcnt(0)
    s_barrier
    v_mfma_f32_16x16x32_bf16 v[20:23], v[172:175], v[156:159], v[20:23]
    ds_read_b128 v[116:119], v2 offset:32768
    v_mfma_f32_16x16x32_bf16 v[28:31], v[172:175], v[160:163], v[28:31]
    ds_read_b64_tr_b16 v[132:133], v4 offset:49152
    v_mfma_f32_16x16x32_bf16 v[36:39], v[172:175], v[164:167], v[36:39]
    ds_read_b64_tr_b16 v[134:135], v4 offset:49664
    v_mfma_f32_16x16x32_bf16 v[44:47], v[172:175], v[168:171], v[44:47]
    ds_read_b128 v[120:123], v2 offset:34816
    v_mfma_f32_16x16x32_bf16 v[48:51], v[176:179], v[168:171], v[48:51]
    ds_read_b128 v[124:127], v2 offset:36864
    v_mfma_f32_16x16x32_bf16 v[40:43], v[176:179], v[164:167], v[40:43]
    ds_read_b128 v[128:131], v2 offset:38912
    v_mfma_f32_16x16x32_bf16 v[32:35], v[176:179], v[160:163], v[32:35]
    ds_read_b64_tr_b16 v[136:137], v5 offset:49152
    v_mfma_f32_16x16x32_bf16 v[24:27], v[176:179], v[156:159], v[24:27]
    ds_read_b64_tr_b16 v[138:139], v5 offset:49664
    v_mfma_f32_16x16x32_bf16 v[52:55], v[156:159], v[180:183], v[52:55]
    ds_read_b64_tr_b16 v[140:141], v4 offset:50176
    v_mfma_f32_16x16x32_bf16 v[60:63], v[160:163], v[180:183], v[60:63]
    ds_read_b64_tr_b16 v[142:143], v4 offset:50688
    v_mfma_f32_16x16x32_bf16 v[68:71], v[164:167], v[180:183], v[68:71]
    ds_read_b64_tr_b16 v[144:145], v5 offset:50176
    v_mfma_f32_16x16x32_bf16 v[76:79], v[168:171], v[180:183], v[76:79]
    ds_read_b64_tr_b16 v[146:147], v5 offset:50688
    v_mfma_f32_16x16x32_bf16 v[80:83], v[168:171], v[184:187], v[80:83]
    ds_read_b64_tr_b16 v[148:149], v4 offset:51200
    v_mfma_f32_16x16x32_bf16 v[72:75], v[164:167], v[184:187], v[72:75]
    ds_read_b64_tr_b16 v[150:151], v4 offset:51712
    v_mfma_f32_16x16x32_bf16 v[64:67], v[160:163], v[184:187], v[64:67]
    ds_read_b64_tr_b16 v[152:153], v5 offset:51200
    v_mfma_f32_16x16x32_bf16 v[56:59], v[156:159], v[184:187], v[56:59]
    ds_read_b64_tr_b16 v[154:155], v5 offset:51712
    v_mfma_f32_16x16x32_bf16 v[84:87], v[156:159], v[188:191], v[84:87]
    v_mfma_f32_16x16x32_bf16 v[92:95], v[160:163], v[188:191], v[92:95]
    v_mfma_f32_16x16x32_bf16 v[100:103], v[164:167], v[188:191], v[100:103]
    v_mfma_f32_16x16x32_bf16 v[108:111], v[168:171], v[188:191], v[108:111]
    v_mfma_f32_16x16x32_bf16 v[112:115], v[168:171], v[192:195], v[112:115]
    v_mfma_f32_16x16x32_bf16 v[104:107], v[164:167], v[192:195], v[104:107]
    v_mfma_f32_16x16x32_bf16 v[96:99], v[160:163], v[192:195], v[96:99]
    v_mfma_f32_16x16x32_bf16 v[88:91], v[156:159], v[192:195], v[88:91]
    s_waitcnt lgkmcnt(13)
    v_mfma_f32_16x16x32_bf16 v[20:23], v[132:135], v[116:119], v[20:23]
    ds_read_b128 v[156:159], v3 offset:32768
    s_waitcnt lgkmcnt(11)
    v_mfma_f32_16x16x32_bf16 v[28:31], v[132:135], v[120:123], v[28:31]
    ds_read_b64_tr_b16 v[172:173], v4 offset:61440
    v_mfma_f32_16x16x32_bf16 v[36:39], v[132:135], v[124:127], v[36:39]
    ds_read_b64_tr_b16 v[174:175], v4 offset:61952
    v_mfma_f32_16x16x32_bf16 v[44:47], v[132:135], v[128:131], v[44:47]
    ds_read_b128 v[160:163], v3 offset:34816
    s_waitcnt lgkmcnt(12)
    v_mfma_f32_16x16x32_bf16 v[48:51], v[136:139], v[128:131], v[48:51]
    ds_read_b128 v[164:167], v3 offset:36864
    v_mfma_f32_16x16x32_bf16 v[40:43], v[136:139], v[124:127], v[40:43]
    ds_read_b128 v[168:171], v3 offset:38912
    v_mfma_f32_16x16x32_bf16 v[32:35], v[136:139], v[120:123], v[32:35]
    ds_read_b64_tr_b16 v[176:177], v5 offset:61440
    v_mfma_f32_16x16x32_bf16 v[24:27], v[136:139], v[116:119], v[24:27]
    ds_read_b64_tr_b16 v[178:179], v5 offset:61952
    s_waitcnt lgkmcnt(14)
    v_mfma_f32_16x16x32_bf16 v[52:55], v[116:119], v[140:143], v[52:55]
    ds_read_b64_tr_b16 v[180:181], v4 offset:62464
    v_mfma_f32_16x16x32_bf16 v[60:63], v[120:123], v[140:143], v[60:63]
    ds_read_b64_tr_b16 v[182:183], v4 offset:62976
    v_mfma_f32_16x16x32_bf16 v[68:71], v[124:127], v[140:143], v[68:71]
    ds_read_b64_tr_b16 v[184:185], v5 offset:62464
    v_mfma_f32_16x16x32_bf16 v[76:79], v[128:131], v[140:143], v[76:79]
    ds_read_b64_tr_b16 v[186:187], v5 offset:62976
    s_waitcnt lgkmcnt(15)
    v_mfma_f32_16x16x32_bf16 v[80:83], v[128:131], v[144:147], v[80:83]
    ds_read_b64_tr_b16 v[188:189], v4 offset:63488
    v_mfma_f32_16x16x32_bf16 v[72:75], v[124:127], v[144:147], v[72:75]
    ds_read_b64_tr_b16 v[190:191], v4 offset:64000
    v_mfma_f32_16x16x32_bf16 v[64:67], v[120:123], v[144:147], v[64:67]
    ds_read_b64_tr_b16 v[192:193], v5 offset:63488
    v_mfma_f32_16x16x32_bf16 v[56:59], v[116:119], v[144:147], v[56:59]
    ds_read_b64_tr_b16 v[194:195], v5 offset:64000
    s_waitcnt lgkmcnt(15)
    v_mfma_f32_16x16x32_bf16 v[84:87], v[116:119], v[148:151], v[84:87]
    v_mfma_f32_16x16x32_bf16 v[92:95], v[120:123], v[148:151], v[92:95]
    v_mfma_f32_16x16x32_bf16 v[100:103], v[124:127], v[148:151], v[100:103]
    v_mfma_f32_16x16x32_bf16 v[108:111], v[128:131], v[148:151], v[108:111]
    s_waitcnt lgkmcnt(15)
    v_mfma_f32_16x16x32_bf16 v[112:115], v[128:131], v[152:155], v[112:115]
    v_mfma_f32_16x16x32_bf16 v[104:107], v[124:127], v[152:155], v[104:107]
    v_mfma_f32_16x16x32_bf16 v[96:99], v[120:123], v[152:155], v[96:99]
    v_mfma_f32_16x16x32_bf16 v[88:91], v[116:119], v[152:155], v[88:91]
    s_waitcnt lgkmcnt(0)
    s_barrier
    v_mfma_f32_16x16x32_bf16 v[20:23], v[172:175], v[156:159], v[20:23]
    ds_read_b128 v[116:119], v2 offset:0
    v_mfma_f32_16x16x32_bf16 v[28:31], v[172:175], v[160:163], v[28:31]
    ds_read_b64_tr_b16 v[132:133], v4 offset:0
    v_mfma_f32_16x16x32_bf16 v[36:39], v[172:175], v[164:167], v[36:39]
    ds_read_b64_tr_b16 v[134:135], v4 offset:512
    v_mfma_f32_16x16x32_bf16 v[44:47], v[172:175], v[168:171], v[44:47]
    ds_read_b128 v[120:123], v2 offset:2048
    v_mfma_f32_16x16x32_bf16 v[48:51], v[176:179], v[168:171], v[48:51]
    ds_read_b128 v[124:127], v2 offset:4096
    v_mfma_f32_16x16x32_bf16 v[40:43], v[176:179], v[164:167], v[40:43]
    ds_read_b128 v[128:131], v2 offset:6144
    v_mfma_f32_16x16x32_bf16 v[32:35], v[176:179], v[160:163], v[32:35]
    ds_read_b64_tr_b16 v[136:137], v5 offset:0
    v_mfma_f32_16x16x32_bf16 v[24:27], v[176:179], v[156:159], v[24:27]
    ds_read_b64_tr_b16 v[138:139], v5 offset:512
    v_mfma_f32_16x16x32_bf16 v[52:55], v[156:159], v[180:183], v[52:55]
    ds_read_b64_tr_b16 v[140:141], v4 offset:1024
    v_mfma_f32_16x16x32_bf16 v[60:63], v[160:163], v[180:183], v[60:63]
    ds_read_b64_tr_b16 v[142:143], v4 offset:1536
    v_mfma_f32_16x16x32_bf16 v[68:71], v[164:167], v[180:183], v[68:71]
    ds_read_b64_tr_b16 v[144:145], v5 offset:1024
    v_mfma_f32_16x16x32_bf16 v[76:79], v[168:171], v[180:183], v[76:79]
    ds_read_b64_tr_b16 v[146:147], v5 offset:1536
    v_mfma_f32_16x16x32_bf16 v[80:83], v[168:171], v[184:187], v[80:83]
    ds_read_b64_tr_b16 v[148:149], v4 offset:2048
    v_mfma_f32_16x16x32_bf16 v[72:75], v[164:167], v[184:187], v[72:75]
    ds_read_b64_tr_b16 v[150:151], v4 offset:2560
    v_mfma_f32_16x16x32_bf16 v[64:67], v[160:163], v[184:187], v[64:67]
    ds_read_b64_tr_b16 v[152:153], v5 offset:2048
    v_mfma_f32_16x16x32_bf16 v[56:59], v[156:159], v[184:187], v[56:59]
    ds_read_b64_tr_b16 v[154:155], v5 offset:2560
    v_mfma_f32_16x16x32_bf16 v[84:87], v[156:159], v[188:191], v[84:87]
    v_mfma_f32_16x16x32_bf16 v[92:95], v[160:163], v[188:191], v[92:95]
    v_mfma_f32_16x16x32_bf16 v[100:103], v[164:167], v[188:191], v[100:103]
    v_mfma_f32_16x16x32_bf16 v[108:111], v[168:171], v[188:191], v[108:111]
    v_mfma_f32_16x16x32_bf16 v[112:115], v[168:171], v[192:195], v[112:115]
    v_mfma_f32_16x16x32_bf16 v[104:107], v[164:167], v[192:195], v[104:107]
    v_mfma_f32_16x16x32_bf16 v[96:99], v[160:163], v[192:195], v[96:99]
    v_mfma_f32_16x16x32_bf16 v[88:91], v[156:159], v[192:195], v[88:91]
    s_waitcnt lgkmcnt(13)
    v_mfma_f32_16x16x32_bf16 v[20:23], v[132:135], v[116:119], v[20:23]
    ds_read_b128 v[156:159], v3 offset:0
    s_waitcnt lgkmcnt(11)
    v_mfma_f32_16x16x32_bf16 v[28:31], v[132:135], v[120:123], v[28:31]
    ds_read_b64_tr_b16 v[172:173], v4 offset:12288
    v_mfma_f32_16x16x32_bf16 v[36:39], v[132:135], v[124:127], v[36:39]
    ds_read_b64_tr_b16 v[174:175], v4 offset:12800
    v_mfma_f32_16x16x32_bf16 v[44:47], v[132:135], v[128:131], v[44:47]
    ds_read_b128 v[160:163], v3 offset:2048
    s_waitcnt lgkmcnt(12)
    v_mfma_f32_16x16x32_bf16 v[48:51], v[136:139], v[128:131], v[48:51]
    ds_read_b128 v[164:167], v3 offset:4096
    v_mfma_f32_16x16x32_bf16 v[40:43], v[136:139], v[124:127], v[40:43]
    ds_read_b128 v[168:171], v3 offset:6144
    v_mfma_f32_16x16x32_bf16 v[32:35], v[136:139], v[120:123], v[32:35]
    ds_read_b64_tr_b16 v[176:177], v5 offset:12288
    v_mfma_f32_16x16x32_bf16 v[24:27], v[136:139], v[116:119], v[24:27]
    ds_read_b64_tr_b16 v[178:179], v5 offset:12800
    s_waitcnt lgkmcnt(14)
    v_mfma_f32_16x16x32_bf16 v[52:55], v[116:119], v[140:143], v[52:55]
    ds_read_b64_tr_b16 v[180:181], v4 offset:13312
    v_mfma_f32_16x16x32_bf16 v[60:63], v[120:123], v[140:143], v[60:63]
    ds_read_b64_tr_b16 v[182:183], v4 offset:13824
    v_mfma_f32_16x16x32_bf16 v[68:71], v[124:127], v[140:143], v[68:71]
    ds_read_b64_tr_b16 v[184:185], v5 offset:13312
    v_mfma_f32_16x16x32_bf16 v[76:79], v[128:131], v[140:143], v[76:79]
    ds_read_b64_tr_b16 v[186:187], v5 offset:13824
    s_waitcnt lgkmcnt(15)
    v_mfma_f32_16x16x32_bf16 v[80:83], v[128:131], v[144:147], v[80:83]
    ds_read_b64_tr_b16 v[188:189], v4 offset:14336
    v_mfma_f32_16x16x32_bf16 v[72:75], v[124:127], v[144:147], v[72:75]
    ds_read_b64_tr_b16 v[190:191], v4 offset:14848
    v_mfma_f32_16x16x32_bf16 v[64:67], v[120:123], v[144:147], v[64:67]
    ds_read_b64_tr_b16 v[192:193], v5 offset:14336
    v_mfma_f32_16x16x32_bf16 v[56:59], v[116:119], v[144:147], v[56:59]
    ds_read_b64_tr_b16 v[194:195], v5 offset:14848
    s_waitcnt lgkmcnt(15)
    v_mfma_f32_16x16x32_bf16 v[84:87], v[116:119], v[148:151], v[84:87]
    v_mfma_f32_16x16x32_bf16 v[92:95], v[120:123], v[148:151], v[92:95]
    v_mfma_f32_16x16x32_bf16 v[100:103], v[124:127], v[148:151], v[100:103]
    v_mfma_f32_16x16x32_bf16 v[108:111], v[128:131], v[148:151], v[108:111]
    s_waitcnt lgkmcnt(15)
    v_mfma_f32_16x16x32_bf16 v[112:115], v[128:131], v[152:155], v[112:115]
    v_mfma_f32_16x16x32_bf16 v[104:107], v[124:127], v[152:155], v[104:107]
    v_mfma_f32_16x16x32_bf16 v[96:99], v[120:123], v[152:155], v[96:99]
    v_mfma_f32_16x16x32_bf16 v[88:91], v[116:119], v[152:155], v[88:91]
    s_waitcnt lgkmcnt(0)
    s_barrier
    v_mfma_f32_16x16x32_bf16 v[20:23], v[172:175], v[156:159], v[20:23]
    ds_read_b128 v[116:119], v2 offset:16384
    v_mfma_f32_16x16x32_bf16 v[28:31], v[172:175], v[160:163], v[28:31]
    ds_read_b64_tr_b16 v[132:133], v4 offset:24576
    v_mfma_f32_16x16x32_bf16 v[36:39], v[172:175], v[164:167], v[36:39]
    ds_read_b64_tr_b16 v[134:135], v4 offset:25088
    v_mfma_f32_16x16x32_bf16 v[44:47], v[172:175], v[168:171], v[44:47]
    ds_read_b128 v[120:123], v2 offset:18432
    v_mfma_f32_16x16x32_bf16 v[48:51], v[176:179], v[168:171], v[48:51]
    ds_read_b128 v[124:127], v2 offset:20480
    v_mfma_f32_16x16x32_bf16 v[40:43], v[176:179], v[164:167], v[40:43]
    ds_read_b128 v[128:131], v2 offset:22528
    v_mfma_f32_16x16x32_bf16 v[32:35], v[176:179], v[160:163], v[32:35]
    ds_read_b64_tr_b16 v[136:137], v5 offset:24576
    v_mfma_f32_16x16x32_bf16 v[24:27], v[176:179], v[156:159], v[24:27]
    ds_read_b64_tr_b16 v[138:139], v5 offset:25088
    v_mfma_f32_16x16x32_bf16 v[52:55], v[156:159], v[180:183], v[52:55]
    ds_read_b64_tr_b16 v[140:141], v4 offset:25600
    v_mfma_f32_16x16x32_bf16 v[60:63], v[160:163], v[180:183], v[60:63]
    ds_read_b64_tr_b16 v[142:143], v4 offset:26112
    v_mfma_f32_16x16x32_bf16 v[68:71], v[164:167], v[180:183], v[68:71]
    ds_read_b64_tr_b16 v[144:145], v5 offset:25600
    v_mfma_f32_16x16x32_bf16 v[76:79], v[168:171], v[180:183], v[76:79]
    ds_read_b64_tr_b16 v[146:147], v5 offset:26112
    v_mfma_f32_16x16x32_bf16 v[80:83], v[168:171], v[184:187], v[80:83]
    ds_read_b64_tr_b16 v[148:149], v4 offset:26624
    v_mfma_f32_16x16x32_bf16 v[72:75], v[164:167], v[184:187], v[72:75]
    ds_read_b64_tr_b16 v[150:151], v4 offset:27136
    v_mfma_f32_16x16x32_bf16 v[64:67], v[160:163], v[184:187], v[64:67]
    ds_read_b64_tr_b16 v[152:153], v5 offset:26624
    v_mfma_f32_16x16x32_bf16 v[56:59], v[156:159], v[184:187], v[56:59]
    ds_read_b64_tr_b16 v[154:155], v5 offset:27136
    v_mfma_f32_16x16x32_bf16 v[84:87], v[156:159], v[188:191], v[84:87]
    v_mfma_f32_16x16x32_bf16 v[92:95], v[160:163], v[188:191], v[92:95]
    v_mfma_f32_16x16x32_bf16 v[100:103], v[164:167], v[188:191], v[100:103]
    v_mfma_f32_16x16x32_bf16 v[108:111], v[168:171], v[188:191], v[108:111]
    v_mfma_f32_16x16x32_bf16 v[112:115], v[168:171], v[192:195], v[112:115]
    v_mfma_f32_16x16x32_bf16 v[104:107], v[164:167], v[192:195], v[104:107]
    v_mfma_f32_16x16x32_bf16 v[96:99], v[160:163], v[192:195], v[96:99]
    v_mfma_f32_16x16x32_bf16 v[88:91], v[156:159], v[192:195], v[88:91]
    s_waitcnt lgkmcnt(13)
    v_mfma_f32_16x16x32_bf16 v[20:23], v[132:135], v[116:119], v[20:23]
    ds_read_b128 v[156:159], v3 offset:16384
    s_waitcnt lgkmcnt(11)
    v_mfma_f32_16x16x32_bf16 v[28:31], v[132:135], v[120:123], v[28:31]
    ds_read_b64_tr_b16 v[172:173], v4 offset:36864
    v_mfma_f32_16x16x32_bf16 v[36:39], v[132:135], v[124:127], v[36:39]
    ds_read_b64_tr_b16 v[174:175], v4 offset:37376
    v_mfma_f32_16x16x32_bf16 v[44:47], v[132:135], v[128:131], v[44:47]
    ds_read_b128 v[160:163], v3 offset:18432
    s_waitcnt lgkmcnt(12)
    v_mfma_f32_16x16x32_bf16 v[48:51], v[136:139], v[128:131], v[48:51]
    ds_read_b128 v[164:167], v3 offset:20480
    v_mfma_f32_16x16x32_bf16 v[40:43], v[136:139], v[124:127], v[40:43]
    ds_read_b128 v[168:171], v3 offset:22528
    v_mfma_f32_16x16x32_bf16 v[32:35], v[136:139], v[120:123], v[32:35]
    ds_read_b64_tr_b16 v[176:177], v5 offset:36864
    v_mfma_f32_16x16x32_bf16 v[24:27], v[136:139], v[116:119], v[24:27]
    ds_read_b64_tr_b16 v[178:179], v5 offset:37376
    s_waitcnt lgkmcnt(14)
    v_mfma_f32_16x16x32_bf16 v[52:55], v[116:119], v[140:143], v[52:55]
    ds_read_b64_tr_b16 v[180:181], v4 offset:37888
    v_mfma_f32_16x16x32_bf16 v[60:63], v[120:123], v[140:143], v[60:63]
    ds_read_b64_tr_b16 v[182:183], v4 offset:38400
    v_mfma_f32_16x16x32_bf16 v[68:71], v[124:127], v[140:143], v[68:71]
    ds_read_b64_tr_b16 v[184:185], v5 offset:37888
    v_mfma_f32_16x16x32_bf16 v[76:79], v[128:131], v[140:143], v[76:79]
    ds_read_b64_tr_b16 v[186:187], v5 offset:38400
    s_waitcnt lgkmcnt(15)
    v_mfma_f32_16x16x32_bf16 v[80:83], v[128:131], v[144:147], v[80:83]
    ds_read_b64_tr_b16 v[188:189], v4 offset:38912
    v_mfma_f32_16x16x32_bf16 v[72:75], v[124:127], v[144:147], v[72:75]
    ds_read_b64_tr_b16 v[190:191], v4 offset:39424
    v_mfma_f32_16x16x32_bf16 v[64:67], v[120:123], v[144:147], v[64:67]
    ds_read_b64_tr_b16 v[192:193], v5 offset:38912
    v_mfma_f32_16x16x32_bf16 v[56:59], v[116:119], v[144:147], v[56:59]
    ds_read_b64_tr_b16 v[194:195], v5 offset:39424
    s_waitcnt lgkmcnt(15)
    v_mfma_f32_16x16x32_bf16 v[84:87], v[116:119], v[148:151], v[84:87]
    v_mfma_f32_16x16x32_bf16 v[92:95], v[120:123], v[148:151], v[92:95]
    v_mfma_f32_16x16x32_bf16 v[100:103], v[124:127], v[148:151], v[100:103]
    v_mfma_f32_16x16x32_bf16 v[108:111], v[128:131], v[148:151], v[108:111]
    s_waitcnt lgkmcnt(15)
    v_mfma_f32_16x16x32_bf16 v[112:115], v[128:131], v[152:155], v[112:115]
    v_mfma_f32_16x16x32_bf16 v[104:107], v[124:127], v[152:155], v[104:107]
    v_mfma_f32_16x16x32_bf16 v[96:99], v[120:123], v[152:155], v[96:99]
    v_mfma_f32_16x16x32_bf16 v[88:91], v[116:119], v[152:155], v[88:91]
    s_waitcnt lgkmcnt(0)
    ds_write_b32 v14, v15
    v_mfma_f32_16x16x32_bf16 v[20:23], v[172:175], v[156:159], v[20:23]
    ds_read_b32 v148, v242 offset:256
    v_mfma_f32_16x16x32_bf16 v[28:31], v[172:175], v[160:163], v[28:31]
    ds_read_b32 v150, v242 offset:320
    v_mfma_f32_16x16x32_bf16 v[36:39], v[172:175], v[164:167], v[36:39]
    ds_read_b32 v152, v242 offset:512
    v_mfma_f32_16x16x32_bf16 v[44:47], v[172:175], v[168:171], v[44:47]
    ds_read_b32 v154, v242 offset:576
    v_mfma_f32_16x16x32_bf16 v[48:51], v[176:179], v[168:171], v[48:51]
    ds_read_b128 v[116:119], v239 offset:0
    v_mfma_f32_16x16x32_bf16 v[40:43], v[176:179], v[164:167], v[40:43]
    ds_read_b128 v[120:123], v239 offset:64
    v_mfma_f32_16x16x32_bf16 v[32:35], v[176:179], v[160:163], v[32:35]
    ds_read_b128 v[124:127], v239 offset:128
    v_mfma_f32_16x16x32_bf16 v[24:27], v[176:179], v[156:159], v[24:27]
    ds_read_b128 v[128:131], v239 offset:192
    v_mfma_f32_16x16x32_bf16 v[52:55], v[156:159], v[180:183], v[52:55]
    ds_read_b128 v[132:135], v239 offset:512
    v_mfma_f32_16x16x32_bf16 v[60:63], v[160:163], v[180:183], v[60:63]
    ds_read_b128 v[136:139], v239 offset:576
    v_mfma_f32_16x16x32_bf16 v[68:71], v[164:167], v[180:183], v[68:71]
    ds_read_b128 v[140:143], v239 offset:640
    v_mfma_f32_16x16x32_bf16 v[76:79], v[168:171], v[180:183], v[76:79]
    ds_read_b128 v[144:147], v239 offset:704
    v_mfma_f32_16x16x32_bf16 v[80:83], v[168:171], v[184:187], v[80:83]
    ds_read_b128 v[212:215], v238 offset:0
    v_mfma_f32_16x16x32_bf16 v[72:75], v[164:167], v[184:187], v[72:75]
    ds_read_b128 v[216:219], v238 offset:64
    v_mfma_f32_16x16x32_bf16 v[64:67], v[160:163], v[184:187], v[64:67]
    ds_read_b32 v230, v243 offset:0
    v_mfma_f32_16x16x32_bf16 v[56:59], v[156:159], v[184:187], v[56:59]
    ds_read_b32 v232, v243 offset:64
    v_mfma_f32_16x16x32_bf16 v[84:87], v[156:159], v[188:191], v[84:87]
    ds_read_b32 v234, v243 offset:128
    v_mfma_f32_16x16x32_bf16 v[92:95], v[160:163], v[188:191], v[92:95]
    ds_read_b32 v236, v243 offset:192
    v_mfma_f32_16x16x32_bf16 v[100:103], v[164:167], v[188:191], v[100:103]
    ds_read_b32 v6, v243 offset:512
    v_mfma_f32_16x16x32_bf16 v[108:111], v[168:171], v[188:191], v[108:111]
    ds_read_b32 v8, v243 offset:576
    v_mfma_f32_16x16x32_bf16 v[112:115], v[168:171], v[192:195], v[112:115]
    ds_read_b32 v10, v243 offset:640
    v_mfma_f32_16x16x32_bf16 v[104:107], v[164:167], v[192:195], v[104:107]
    ds_read_b32 v12, v243 offset:704
    v_mfma_f32_16x16x32_bf16 v[96:99], v[160:163], v[192:195], v[96:99]
    v_mfma_f32_16x16x32_bf16 v[88:91], v[156:159], v[192:195], v[88:91]
    s_waitcnt lgkmcnt(10)
    .p2align 3
    v_pk_fma_f32 v[52:53], v[116:117], v[148:149], v[52:53] op_sel_hi:[1,0,1] neg_lo:[1,0,0] neg_hi:[1,0,0]
    v_pk_fma_f32 v[54:55], v[118:119], v[148:149], v[54:55] op_sel_hi:[1,0,1] neg_lo:[1,0,0] neg_hi:[1,0,0]
    v_pk_fma_f32 v[56:57], v[116:117], v[150:151], v[56:57] op_sel_hi:[1,0,1] neg_lo:[1,0,0] neg_hi:[1,0,0]
    v_pk_fma_f32 v[58:59], v[118:119], v[150:151], v[58:59] op_sel_hi:[1,0,1] neg_lo:[1,0,0] neg_hi:[1,0,0]
    v_pk_fma_f32 v[60:61], v[120:121], v[148:149], v[60:61] op_sel_hi:[1,0,1] neg_lo:[1,0,0] neg_hi:[1,0,0]
    v_pk_fma_f32 v[62:63], v[122:123], v[148:149], v[62:63] op_sel_hi:[1,0,1] neg_lo:[1,0,0] neg_hi:[1,0,0]
    v_pk_fma_f32 v[64:65], v[120:121], v[150:151], v[64:65] op_sel_hi:[1,0,1] neg_lo:[1,0,0] neg_hi:[1,0,0]
    v_pk_fma_f32 v[66:67], v[122:123], v[150:151], v[66:67] op_sel_hi:[1,0,1] neg_lo:[1,0,0] neg_hi:[1,0,0]
    v_pk_fma_f32 v[68:69], v[124:125], v[148:149], v[68:69] op_sel_hi:[1,0,1] neg_lo:[1,0,0] neg_hi:[1,0,0]
    v_pk_fma_f32 v[70:71], v[126:127], v[148:149], v[70:71] op_sel_hi:[1,0,1] neg_lo:[1,0,0] neg_hi:[1,0,0]
    v_pk_fma_f32 v[72:73], v[124:125], v[150:151], v[72:73] op_sel_hi:[1,0,1] neg_lo:[1,0,0] neg_hi:[1,0,0]
    v_pk_fma_f32 v[74:75], v[126:127], v[150:151], v[74:75] op_sel_hi:[1,0,1] neg_lo:[1,0,0] neg_hi:[1,0,0]
    v_pk_fma_f32 v[76:77], v[128:129], v[148:149], v[76:77] op_sel_hi:[1,0,1] neg_lo:[1,0,0] neg_hi:[1,0,0]
    v_pk_fma_f32 v[78:79], v[130:131], v[148:149], v[78:79] op_sel_hi:[1,0,1] neg_lo:[1,0,0] neg_hi:[1,0,0]
    v_pk_fma_f32 v[80:81], v[128:129], v[150:151], v[80:81] op_sel_hi:[1,0,1] neg_lo:[1,0,0] neg_hi:[1,0,0]
    v_pk_fma_f32 v[82:83], v[130:131], v[150:151], v[82:83] op_sel_hi:[1,0,1] neg_lo:[1,0,0] neg_hi:[1,0,0]
    v_pk_mul_f32 v[52:53], v[52:53], v[132:133]
    v_pk_mul_f32 v[54:55], v[54:55], v[134:135]
    v_pk_mul_f32 v[56:57], v[56:57], v[132:133]
    v_pk_mul_f32 v[58:59], v[58:59], v[134:135]
    v_pk_mul_f32 v[60:61], v[60:61], v[136:137]
    v_pk_mul_f32 v[62:63], v[62:63], v[138:139]
    v_pk_mul_f32 v[64:65], v[64:65], v[136:137]
    v_pk_mul_f32 v[66:67], v[66:67], v[138:139]
    v_pk_mul_f32 v[68:69], v[68:69], v[140:141]
    v_pk_mul_f32 v[70:71], v[70:71], v[142:143]
    v_pk_mul_f32 v[72:73], v[72:73], v[140:141]
    v_pk_mul_f32 v[74:75], v[74:75], v[142:143]
    v_pk_mul_f32 v[76:77], v[76:77], v[144:145]
    v_pk_mul_f32 v[78:79], v[78:79], v[146:147]
    v_pk_mul_f32 v[80:81], v[80:81], v[144:145]
    v_pk_mul_f32 v[82:83], v[82:83], v[146:147]
    v_pk_fma_f32 v[84:85], v[116:117], v[152:153], v[84:85] op_sel_hi:[1,0,1] neg_lo:[1,0,0] neg_hi:[1,0,0]
    v_pk_fma_f32 v[86:87], v[118:119], v[152:153], v[86:87] op_sel_hi:[1,0,1] neg_lo:[1,0,0] neg_hi:[1,0,0]
    v_pk_fma_f32 v[88:89], v[116:117], v[154:155], v[88:89] op_sel_hi:[1,0,1] neg_lo:[1,0,0] neg_hi:[1,0,0]
    v_pk_fma_f32 v[90:91], v[118:119], v[154:155], v[90:91] op_sel_hi:[1,0,1] neg_lo:[1,0,0] neg_hi:[1,0,0]
    v_pk_fma_f32 v[92:93], v[120:121], v[152:153], v[92:93] op_sel_hi:[1,0,1] neg_lo:[1,0,0] neg_hi:[1,0,0]
    v_pk_fma_f32 v[94:95], v[122:123], v[152:153], v[94:95] op_sel_hi:[1,0,1] neg_lo:[1,0,0] neg_hi:[1,0,0]
    v_pk_fma_f32 v[96:97], v[120:121], v[154:155], v[96:97] op_sel_hi:[1,0,1] neg_lo:[1,0,0] neg_hi:[1,0,0]
    v_pk_fma_f32 v[98:99], v[122:123], v[154:155], v[98:99] op_sel_hi:[1,0,1] neg_lo:[1,0,0] neg_hi:[1,0,0]
    v_pk_fma_f32 v[100:101], v[124:125], v[152:153], v[100:101] op_sel_hi:[1,0,1] neg_lo:[1,0,0] neg_hi:[1,0,0]
    v_pk_fma_f32 v[102:103], v[126:127], v[152:153], v[102:103] op_sel_hi:[1,0,1] neg_lo:[1,0,0] neg_hi:[1,0,0]
    v_pk_fma_f32 v[104:105], v[124:125], v[154:155], v[104:105] op_sel_hi:[1,0,1] neg_lo:[1,0,0] neg_hi:[1,0,0]
    v_pk_fma_f32 v[106:107], v[126:127], v[154:155], v[106:107] op_sel_hi:[1,0,1] neg_lo:[1,0,0] neg_hi:[1,0,0]
    v_pk_fma_f32 v[108:109], v[128:129], v[152:153], v[108:109] op_sel_hi:[1,0,1] neg_lo:[1,0,0] neg_hi:[1,0,0]
    v_pk_fma_f32 v[110:111], v[130:131], v[152:153], v[110:111] op_sel_hi:[1,0,1] neg_lo:[1,0,0] neg_hi:[1,0,0]
    v_pk_fma_f32 v[112:113], v[128:129], v[154:155], v[112:113] op_sel_hi:[1,0,1] neg_lo:[1,0,0] neg_hi:[1,0,0]
    v_pk_fma_f32 v[114:115], v[130:131], v[154:155], v[114:115] op_sel_hi:[1,0,1] neg_lo:[1,0,0] neg_hi:[1,0,0]
    v_pk_mul_f32 v[84:85], v[84:85], v[132:133]
    v_pk_mul_f32 v[86:87], v[86:87], v[134:135]
    v_pk_mul_f32 v[88:89], v[88:89], v[132:133]
    v_pk_mul_f32 v[90:91], v[90:91], v[134:135]
    v_pk_mul_f32 v[92:93], v[92:93], v[136:137]
    v_pk_mul_f32 v[94:95], v[94:95], v[138:139]
    v_pk_mul_f32 v[96:97], v[96:97], v[136:137]
    v_pk_mul_f32 v[98:99], v[98:99], v[138:139]
    v_pk_mul_f32 v[100:101], v[100:101], v[140:141]
    v_pk_mul_f32 v[102:103], v[102:103], v[142:143]
    v_pk_mul_f32 v[104:105], v[104:105], v[140:141]
    v_pk_mul_f32 v[106:107], v[106:107], v[142:143]
    v_pk_mul_f32 v[108:109], v[108:109], v[144:145]
    v_pk_mul_f32 v[110:111], v[110:111], v[146:147]
    v_pk_mul_f32 v[112:113], v[112:113], v[144:145]
    v_pk_mul_f32 v[114:115], v[114:115], v[146:147]
    v_mov_b32 v192, 0x3f803f80
    v_mov_b32 v193, 0x3f803f80
    v_mov_b32 v194, 0x3f803f80
    v_mov_b32 v195, 0x3f803f80
    .p2align 3
    v_exp_f32 v196, v52
    v_exp_f32 v197, v53
    v_exp_f32 v198, v54
    v_exp_f32 v199, v55
    v_exp_f32 v200, v56
    v_exp_f32 v201, v57
    v_exp_f32 v202, v58
    v_exp_f32 v203, v59
    v_exp_f32 v204, v60
    v_exp_f32 v205, v61
    v_exp_f32 v206, v62
    v_exp_f32 v207, v63
    v_exp_f32 v208, v64
    v_exp_f32 v209, v65
    v_exp_f32 v210, v66
    v_exp_f32 v211, v67
    v_pk_fma_f32 v[52:53], v[52:53], v[224:225], v[226:227] op_sel_hi:[1,0,0]
    v_pk_fma_f32 v[54:55], v[54:55], v[224:225], v[226:227] op_sel_hi:[1,0,0]
    v_pk_fma_f32 v[56:57], v[56:57], v[224:225], v[226:227] op_sel_hi:[1,0,0]
    v_pk_fma_f32 v[58:59], v[58:59], v[224:225], v[226:227] op_sel_hi:[1,0,0]
    v_pk_fma_f32 v[60:61], v[60:61], v[224:225], v[226:227] op_sel_hi:[1,0,0]
    v_pk_fma_f32 v[62:63], v[62:63], v[224:225], v[226:227] op_sel_hi:[1,0,0]
    v_pk_fma_f32 v[64:65], v[64:65], v[224:225], v[226:227] op_sel_hi:[1,0,0]
    v_pk_fma_f32 v[66:67], v[66:67], v[224:225], v[226:227] op_sel_hi:[1,0,0]
    v_med3_f32 v196, v52, v196, 1.0
    v_med3_f32 v197, v53, v197, 1.0
    v_med3_f32 v198, v54, v198, 1.0
    v_med3_f32 v199, v55, v199, 1.0
    v_med3_f32 v200, v56, v200, 1.0
    v_med3_f32 v201, v57, v201, 1.0
    v_med3_f32 v202, v58, v202, 1.0
    v_med3_f32 v203, v59, v203, 1.0
    v_med3_f32 v204, v60, v204, 1.0
    v_med3_f32 v205, v61, v205, 1.0
    v_med3_f32 v206, v62, v206, 1.0
    v_med3_f32 v207, v63, v207, 1.0
    v_med3_f32 v208, v64, v208, 1.0
    v_med3_f32 v209, v65, v209, 1.0
    v_med3_f32 v210, v66, v210, 1.0
    v_med3_f32 v211, v67, v211, 1.0
    v_pk_add_f32 v[196:197], v[196:197], v[228:229] op_sel_hi:[1,0]
    v_pk_add_f32 v[198:199], v[198:199], v[228:229] op_sel_hi:[1,0]
    v_pk_add_f32 v[200:201], v[200:201], v[228:229] op_sel_hi:[1,0]
    v_pk_add_f32 v[202:203], v[202:203], v[228:229] op_sel_hi:[1,0]
    v_pk_add_f32 v[204:205], v[204:205], v[228:229] op_sel_hi:[1,0]
    v_pk_add_f32 v[206:207], v[206:207], v[228:229] op_sel_hi:[1,0]
    v_pk_add_f32 v[208:209], v[208:209], v[228:229] op_sel_hi:[1,0]
    v_pk_add_f32 v[210:211], v[210:211], v[228:229] op_sel_hi:[1,0]
    v_cvt_pk_bf16_f32 v52, v196, v197
    v_cvt_pk_bf16_f32 v53, v198, v199
    v_cvt_pk_bf16_f32 v56, v200, v201
    v_cvt_pk_bf16_f32 v57, v202, v203
    v_cvt_pk_bf16_f32 v54, v204, v205
    v_cvt_pk_bf16_f32 v55, v206, v207
    v_cvt_pk_bf16_f32 v58, v208, v209
    v_cvt_pk_bf16_f32 v59, v210, v211
    v_cvt_pk_bf16_f32 v156, v84, v85
    v_cvt_pk_bf16_f32 v157, v86, v87
    v_cvt_pk_bf16_f32 v160, v88, v89
    v_cvt_pk_bf16_f32 v161, v90, v91
    v_cvt_pk_bf16_f32 v158, v92, v93
    v_cvt_pk_bf16_f32 v159, v94, v95
    v_cvt_pk_bf16_f32 v162, v96, v97
    v_cvt_pk_bf16_f32 v163, v98, v99
    s_nop 1
    v_mfma_f32_16x16x32_bf16 v[172:175], v[52:55], v[156:159], 0
    v_mfma_f32_16x16x32_bf16 v[180:183], v[52:55], v[192:195], 0
    v_mfma_f32_16x16x32_bf16 v[176:179], v[56:59], v[160:163], 0
    v_mfma_f32_16x16x32_bf16 v[184:187], v[56:59], v[192:195], 0
    .p2align 3
    v_exp_f32 v196, v68
    v_exp_f32 v197, v69
    v_exp_f32 v198, v70
    v_exp_f32 v199, v71
    v_exp_f32 v200, v72
    v_exp_f32 v201, v73
    v_exp_f32 v202, v74
    v_exp_f32 v203, v75
    v_exp_f32 v204, v76
    v_exp_f32 v205, v77
    v_exp_f32 v206, v78
    v_exp_f32 v207, v79
    v_exp_f32 v208, v80
    v_exp_f32 v209, v81
    v_exp_f32 v210, v82
    v_exp_f32 v211, v83
    v_pk_fma_f32 v[68:69], v[68:69], v[224:225], v[226:227] op_sel_hi:[1,0,0]
    v_pk_fma_f32 v[70:71], v[70:71], v[224:225], v[226:227] op_sel_hi:[1,0,0]
    v_pk_fma_f32 v[72:73], v[72:73], v[224:225], v[226:227] op_sel_hi:[1,0,0]
    v_pk_fma_f32 v[74:75], v[74:75], v[224:225], v[226:227] op_sel_hi:[1,0,0]
    v_pk_fma_f32 v[76:77], v[76:77], v[224:225], v[226:227] op_sel_hi:[1,0,0]
    v_pk_fma_f32 v[78:79], v[78:79], v[224:225], v[226:227] op_sel_hi:[1,0,0]
    v_pk_fma_f32 v[80:81], v[80:81], v[224:225], v[226:227] op_sel_hi:[1,0,0]
    v_pk_fma_f32 v[82:83], v[82:83], v[224:225], v[226:227] op_sel_hi:[1,0,0]
    v_med3_f32 v196, v68, v196, 1.0
    v_med3_f32 v197, v69, v197, 1.0
    v_med3_f32 v198, v70, v198, 1.0
    v_med3_f32 v199, v71, v199, 1.0
    v_med3_f32 v200, v72, v200, 1.0
    v_med3_f32 v201, v73, v201, 1.0
    v_med3_f32 v202, v74, v202, 1.0
    v_med3_f32 v203, v75, v203, 1.0
    v_med3_f32 v204, v76, v204, 1.0
    v_med3_f32 v205, v77, v205, 1.0
    v_med3_f32 v206, v78, v206, 1.0
    v_med3_f32 v207, v79, v207, 1.0
    v_med3_f32 v208, v80, v208, 1.0
    v_med3_f32 v209, v81, v209, 1.0
    v_med3_f32 v210, v82, v210, 1.0
    v_med3_f32 v211, v83, v211, 1.0
    v_pk_add_f32 v[196:197], v[196:197], v[228:229] op_sel_hi:[1,0]
    v_pk_add_f32 v[198:199], v[198:199], v[228:229] op_sel_hi:[1,0]
    v_pk_add_f32 v[200:201], v[200:201], v[228:229] op_sel_hi:[1,0]
    v_pk_add_f32 v[202:203], v[202:203], v[228:229] op_sel_hi:[1,0]
    v_pk_add_f32 v[204:205], v[204:205], v[228:229] op_sel_hi:[1,0]
    v_pk_add_f32 v[206:207], v[206:207], v[228:229] op_sel_hi:[1,0]
    v_pk_add_f32 v[208:209], v[208:209], v[228:229] op_sel_hi:[1,0]
    v_pk_add_f32 v[210:211], v[210:211], v[228:229] op_sel_hi:[1,0]
    v_cvt_pk_bf16_f32 v68, v196, v197
    v_cvt_pk_bf16_f32 v69, v198, v199
    v_cvt_pk_bf16_f32 v72, v200, v201
    v_cvt_pk_bf16_f32 v73, v202, v203
    v_cvt_pk_bf16_f32 v70, v204, v205
    v_cvt_pk_bf16_f32 v71, v206, v207
    v_cvt_pk_bf16_f32 v74, v208, v209
    v_cvt_pk_bf16_f32 v75, v210, v211
    v_cvt_pk_bf16_f32 v164, v100, v101
    v_cvt_pk_bf16_f32 v165, v102, v103
    v_cvt_pk_bf16_f32 v168, v104, v105
    v_cvt_pk_bf16_f32 v169, v106, v107
    v_cvt_pk_bf16_f32 v166, v108, v109
    v_cvt_pk_bf16_f32 v167, v110, v111
    v_cvt_pk_bf16_f32 v170, v112, v113
    v_cvt_pk_bf16_f32 v171, v114, v115
    s_nop 1
    v_mfma_f32_16x16x32_bf16 v[172:175], v[68:71], v[164:167], v[172:175]
    v_mfma_f32_16x16x32_bf16 v[180:183], v[68:71], v[192:195], v[180:183]
    v_mfma_f32_16x16x32_bf16 v[176:179], v[72:75], v[168:171], v[176:179]
    v_mfma_f32_16x16x32_bf16 v[184:187], v[72:75], v[192:195], v[184:187]
    ds_write_b32 v14, v15 offset:64
    v_mov_b32 v87, s61
    v_mov_b32 v91, s61
    v_mov_b32 v95, s61
    s_nop 4
    .p2align 3
    v_cndmask_b32 v180, v184, v180, s[86:87]
    v_cndmask_b32 v181, v185, v181, s[86:87]
    v_cndmask_b32 v182, v186, v182, s[86:87]
    v_cndmask_b32 v183, v187, v183, s[86:87]
    v_cndmask_b32 v84, v178, v172, s[66:67]
    v_cndmask_b32 v85, v179, v173, s[66:67]
    v_cndmask_b32 v86, v180, v174, s[66:67]
    v_cndmask_b32 v88, v181, v175, s[66:67]
    v_cndmask_b32 v89, v182, v176, s[66:67]
    v_cndmask_b32 v90, v183, v177, s[66:67]
    ds_write_b128 v249, v[84:87]
    ds_write_b128 v249, v[88:91] offset:1024
    v_cndmask_b32 v186, v172, v178, s[66:67]
    v_cndmask_b32 v187, v173, v179, s[66:67]
    v_cndmask_b32 v188, v174, v180, s[66:67]
    v_cndmask_b32 v189, v175, v181, s[66:67]
    v_cndmask_b32 v190, v176, v182, s[66:67]
    v_cndmask_b32 v191, v177, v183, s[66:67]
    s_mov_b32 s85, 0
L_x1:
    ds_read_b128 v[100:103], v250
    ds_read_b128 v[104:107], v250 offset:1024
    s_add_u32 s85, s85, 1
    s_waitcnt lgkmcnt(0)
    v_cmp_ne_u32 vcc, s61, v103
    v_cmp_ne_u32 s[68:69], s61, v107
    s_cmp_gt_u32 s85, 0x40000
    s_cbranch_scc1 L_x1d
    s_or_b64 vcc, vcc, s[68:69]
    s_cbranch_vccnz L_x1
L_x1d:
    v_add_f32 v186, v186, v100
    v_add_f32 v187, v187, v101
    v_add_f32 v188, v188, v102
    v_add_f32 v189, v189, v104
    v_add_f32 v190, v190, v105
    v_add_f32 v191, v191, v106
    v_cvt_pk_bf16_f32 v92, v186, v187
    v_cvt_pk_bf16_f32 v93, v188, v189
    v_cvt_pk_bf16_f32 v94, v190, v191
    buffer_store_dwordx4 v[92:95], v1, s[40:43], s70 offen sc1
    .p2align 3
    v_pk_fma_f32 v[20:21], v[230:231], v[212:213], v[20:21] op_sel_hi:[0,1,1] neg_lo:[1,0,0] neg_hi:[1,0,0]
    v_pk_fma_f32 v[22:23], v[230:231], v[214:215], v[22:23] op_sel_hi:[0,1,1] neg_lo:[1,0,0] neg_hi:[1,0,0]
    v_pk_fma_f32 v[24:25], v[230:231], v[216:217], v[24:25] op_sel_hi:[0,1,1] neg_lo:[1,0,0] neg_hi:[1,0,0]
    v_pk_fma_f32 v[26:27], v[230:231], v[218:219], v[26:27] op_sel_hi:[0,1,1] neg_lo:[1,0,0] neg_hi:[1,0,0]
    v_pk_fma_f32 v[28:29], v[232:233], v[212:213], v[28:29] op_sel_hi:[0,1,1] neg_lo:[1,0,0] neg_hi:[1,0,0]
    v_pk_fma_f32 v[30:31], v[232:233], v[214:215], v[30:31] op_sel_hi:[0,1,1] neg_lo:[1,0,0] neg_hi:[1,0,0]
    v_pk_fma_f32 v[32:33], v[232:233], v[216:217], v[32:33] op_sel_hi:[0,1,1] neg_lo:[1,0,0] neg_hi:[1,0,0]
    v_pk_fma_f32 v[34:35], v[232:233], v[218:219], v[34:35] op_sel_hi:[0,1,1] neg_lo:[1,0,0] neg_hi:[1,0,0]
    v_pk_fma_f32 v[36:37], v[234:235], v[212:213], v[36:37] op_sel_hi:[0,1,1] neg_lo:[1,0,0] neg_hi:[1,0,0]
    v_pk_fma_f32 v[38:39], v[234:235], v[214:215], v[38:39] op_sel_hi:[0,1,1] neg_lo:[1,0,0] neg_hi:[1,0,0]
    v_pk_fma_f32 v[40:41], v[234:235], v[216:217], v[40:41] op_sel_hi:[0,1,1] neg_lo:[1,0,0] neg_hi:[1,0,0]
    v_pk_fma_f32 v[42:43], v[234:235], v[218:219], v[42:43] op_sel_hi:[0,1,1] neg_lo:[1,0,0] neg_hi:[1,0,0]
    v_pk_fma_f32 v[44:45], v[236:237], v[212:213], v[44:45] op_sel_hi:[0,1,1] neg_lo:[1,0,0] neg_hi:[1,0,0]
    v_pk_fma_f32 v[46:47], v[236:237], v[214:215], v[46:47] op_sel_hi:[0,1,1] neg_lo:[1,0,0] neg_hi:[1,0,0]
    v_pk_fma_f32 v[48:49], v[236:237], v[216:217], v[48:49] op_sel_hi:[0,1,1] neg_lo:[1,0,0] neg_hi:[1,0,0]
    v_pk_fma_f32 v[50:51], v[236:237], v[218:219], v[50:51] op_sel_hi:[0,1,1] neg_lo:[1,0,0] neg_hi:[1,0,0]
    v_pk_mul_f32 v[20:21], v[20:21], v[6:7] op_sel_hi:[1,0]
    v_pk_mul_f32 v[22:23], v[22:23], v[6:7] op_sel_hi:[1,0]
    v_pk_mul_f32 v[24:25], v[24:25], v[6:7] op_sel_hi:[1,0]
    v_pk_mul_f32 v[26:27], v[26:27], v[6:7] op_sel_hi:[1,0]
    v_pk_mul_f32 v[28:29], v[28:29], v[8:9] op_sel_hi:[1,0]
    v_pk_mul_f32 v[30:31], v[30:31], v[8:9] op_sel_hi:[1,0]
    v_pk_mul_f32 v[32:33], v[32:33], v[8:9] op_sel_hi:[1,0]
    v_pk_mul_f32 v[34:35], v[34:35], v[8:9] op_sel_hi:[1,0]
    v_pk_mul_f32 v[36:37], v[36:37], v[10:11] op_sel_hi:[1,0]
    v_pk_mul_f32 v[38:39], v[38:39], v[10:11] op_sel_hi:[1,0]
    v_pk_mul_f32 v[40:41], v[40:41], v[10:11] op_sel_hi:[1,0]
    v_pk_mul_f32 v[42:43], v[42:43], v[10:11] op_sel_hi:[1,0]
    v_pk_mul_f32 v[44:45], v[44:45], v[12:13] op_sel_hi:[1,0]
    v_pk_mul_f32 v[46:47], v[46:47], v[12:13] op_sel_hi:[1,0]
    v_pk_mul_f32 v[48:49], v[48:49], v[12:13] op_sel_hi:[1,0]
    v_pk_mul_f32 v[50:51], v[50:51], v[12:13] op_sel_hi:[1,0]
    .p2align 3
    v_exp_f32 v196, v20
    v_exp_f32 v197, v21
    v_exp_f32 v198, v22
    v_exp_f32 v199, v23
    v_exp_f32 v200, v24
    v_exp_f32 v201, v25
    v_exp_f32 v202, v26
    v_exp_f32 v203, v27
    v_exp_f32 v204, v28
    v_exp_f32 v205, v29
    v_exp_f32 v206, v30
    v_exp_f32 v207, v31
    v_exp_f32 v208, v32
    v_exp_f32 v209, v33
    v_exp_f32 v210, v34
    v_exp_f32 v211, v35
    v_pk_fma_f32 v[20:21], v[20:21], v[224:225], v[226:227] op_sel_hi:[1,0,0]
    v_pk_fma_f32 v[22:23], v[22:23], v[224:225], v[226:227] op_sel_hi:[1,0,0]
    v_pk_fma_f32 v[24:25], v[24:25], v[224:225], v[226:227] op_sel_hi:[1,0,0]
    v_pk_fma_f32 v[26:27], v[26:27], v[224:225], v[226:227] op_sel_hi:[1,0,0]
    v_pk_fma_f32 v[28:29], v[28:29], v[224:225], v[226:227] op_sel_hi:[1,0,0]
    v_pk_fma_f32 v[30:31], v[30:31], v[224:225], v[226:227] op_sel_hi:[1,0,0]
    v_pk_fma_f32 v[32:33], v[32:33], v[224:225], v[226:227] op_sel_hi:[1,0,0]
    v_pk_fma_f32 v[34:35], v[34:35], v[224:225], v[226:227] op_sel_hi:[1,0,0]
    v_med3_f32 v196, v20, v196, 1.0
    v_med3_f32 v197, v21, v197, 1.0
    v_med3_f32 v198, v22, v198, 1.0
    v_med3_f32 v199, v23, v199, 1.0
    v_med3_f32 v200, v24, v200, 1.0
    v_med3_f32 v201, v25, v201, 1.0
    v_med3_f32 v202, v26, v202, 1.0
    v_med3_f32 v203, v27, v203, 1.0
    v_med3_f32 v204, v28, v204, 1.0
    v_med3_f32 v205, v29, v205, 1.0
    v_med3_f32 v206, v30, v206, 1.0
    v_med3_f32 v207, v31, v207, 1.0
    v_med3_f32 v208, v32, v208, 1.0
    v_med3_f32 v209, v33, v209, 1.0
    v_med3_f32 v210, v34, v210, 1.0
    v_med3_f32 v211, v35, v211, 1.0
    v_pk_add_f32 v[196:197], v[196:197], v[228:229] op_sel_hi:[1,0]
    v_pk_add_f32 v[198:199], v[198:199], v[228:229] op_sel_hi:[1,0]
    v_pk_add_f32 v[200:201], v[200:201], v[228:229] op_sel_hi:[1,0]
    v_pk_add_f32 v[202:203], v[202:203], v[228:229] op_sel_hi:[1,0]
    v_pk_add_f32 v[204:205], v[204:205], v[228:229] op_sel_hi:[1,0]
    v_pk_add_f32 v[206:207], v[206:207], v[228:229] op_sel_hi:[1,0]
    v_pk_add_f32 v[208:209], v[208:209], v[228:229] op_sel_hi:[1,0]
    v_pk_add_f32 v[210:211], v[210:211], v[228:229] op_sel_hi:[1,0]
    v_cvt_pk_bf16_f32 v20, v196, v197
    v_cvt_pk_bf16_f32 v21, v198, v199
    v_cvt_pk_bf16_f32 v22, v200, v201
    v_cvt_pk_bf16_f32 v23, v202, v203
    v_cvt_pk_bf16_f32 v24, v204, v205
    v_cvt_pk_bf16_f32 v25, v206, v207
    v_cvt_pk_bf16_f32 v26, v208, v209
    v_cvt_pk_bf16_f32 v27, v210, v211
    .p2align 3
    v_exp_f32 v196, v36
    v_exp_f32 v197, v37
    v_exp_f32 v198, v38
    v_exp_f32 v199, v39
    v_exp_f32 v200, v40
    v_exp_f32 v201, v41
    v_exp_f32 v202, v42
    v_exp_f32 v203, v43
    v_exp_f32 v204, v44
    v_exp_f32 v205, v45
    v_exp_f32 v206, v46
    v_exp_f32 v207, v47
    v_exp_f32 v208, v48
    v_exp_f32 v209, v49
    v_exp_f32 v210, v50
    v_exp_f32 v211, v51
    v_pk_fma_f32 v[36:37], v[36:37], v[224:225], v[226:227] op_sel_hi:[1,0,0]
    v_pk_fma_f32 v[38:39], v[38:39], v[224:225], v[226:227] op_sel_hi:[1,0,0]
    v_pk_fma_f32 v[40:41], v[40:41], v[224:225], v[226:227] op_sel_hi:[1,0,0]
    v_pk_fma_f32 v[42:43], v[42:43], v[224:225], v[226:227] op_sel_hi:[1,0,0]
    v_pk_fma_f32 v[44:45], v[44:45], v[224:225], v[226:227] op_sel_hi:[1,0,0]
    v_pk_fma_f32 v[46:47], v[46:47], v[224:225], v[226:227] op_sel_hi:[1,0,0]
    v_pk_fma_f32 v[48:49], v[48:49], v[224:225], v[226:227] op_sel_hi:[1,0,0]
    v_pk_fma_f32 v[50:51], v[50:51], v[224:225], v[226:227] op_sel_hi:[1,0,0]
    v_med3_f32 v196, v36, v196, 1.0
    v_med3_f32 v197, v37, v197, 1.0
    v_med3_f32 v198, v38, v198, 1.0
    v_med3_f32 v199, v39, v199, 1.0
    v_med3_f32 v200, v40, v200, 1.0
    v_med3_f32 v201, v41, v201, 1.0
    v_med3_f32 v202, v42, v202, 1.0
    v_med3_f32 v203, v43, v203, 1.0
    v_med3_f32 v204, v44, v204, 1.0
    v_med3_f32 v205, v45, v205, 1.0
    v_med3_f32 v206, v46, v206, 1.0
    v_med3_f32 v207, v47, v207, 1.0
    v_med3_f32 v208, v48, v208, 1.0
    v_med3_f32 v209, v49, v209, 1.0
    v_med3_f32 v210, v50, v210, 1.0
    v_med3_f32 v211, v51, v211, 1.0
    v_pk_add_f32 v[196:197], v[196:197], v[228:229] op_sel_hi:[1,0]
    v_pk_add_f32 v[198:199], v[198:199], v[228:229] op_sel_hi:[1,0]
    v_pk_add_f32 v[200:201], v[200:201], v[228:229] op_sel_hi:[1,0]
    v_pk_add_f32 v[202:203], v[202:203], v[228:229] op_sel_hi:[1,0]
    v_pk_add_f32 v[204:205], v[204:205], v[228:229] op_sel_hi:[1,0]
    v_pk_add_f32 v[206:207], v[206:207], v[228:229] op_sel_hi:[1,0]
    v_pk_add_f32 v[208:209], v[208:209], v[228:229] op_sel_hi:[1,0]
    v_pk_add_f32 v[210:211], v[210:211], v[228:229] op_sel_hi:[1,0]
    v_cvt_pk_bf16_f32 v36, v196, v197
    v_cvt_pk_bf16_f32 v37, v198, v199
    v_cvt_pk_bf16_f32 v38, v200, v201
    v_cvt_pk_bf16_f32 v39, v202, v203
    v_cvt_pk_bf16_f32 v40, v204, v205
    v_cvt_pk_bf16_f32 v41, v206, v207
    v_cvt_pk_bf16_f32 v42, v208, v209
    v_cvt_pk_bf16_f32 v43, v210, v211
    s_mov_b32 s82, 0
    s_mov_b32 s85, 0
L_spb2d:
    ds_read_b32 v9, v254 offset:96
    s_add_u32 s85, s85, 1
    s_waitcnt lgkmcnt(0)
    v_cmp_ne_u32 vcc, 1, v9
    s_cmp_gt_u32 s85, 0x40000
    s_cbranch_scc1 L_sdb2d
    s_cbranch_vccnz L_spb2d
L_sdb2d:
L_kv_gather:
    s_mov_b32 s85, 0
L_spkv:
    buffer_load_dword v9, v253, s[40:43], s65 offen offset:12 sc1
    s_add_u32 s85, s85, 1
    s_waitcnt vmcnt(0)
    v_cmp_ne_u32 vcc, s61, v9
    s_cmp_gt_u32 s85, 0x8000
    s_cbranch_scc1 L_sdkv
    s_cbranch_vccz L_sdkv
    s_sleep 2
    s_branch L_spkv
L_sdkv:
L_kv_go:
    s_setprio 3
    s_lshl1_add_u32 s79, s55, 0
    s_and_b32 s79, s79, 14
    s_lshl_b32 s79, s79, 11
    s_add_u32 s79, s79, s65
    buffer_load_dwordx4 v[116:119], v1, s[40:43], s79 offen sc1
    buffer_load_dwordx4 v[120:123], v1, s[40:43], s79 offen offset:2048 sc1
    s_lshl1_add_u32 s79, s55, 2
    s_and_b32 s79, s79, 14
    s_lshl_b32 s79, s79, 11
    s_add_u32 s79, s79, s65
    buffer_load_dwordx4 v[124:127], v1, s[40:43], s79 offen sc1
    buffer_load_dwordx4 v[128:131], v1, s[40:43], s79 offen offset:2048 sc1
    s_lshl1_add_u32 s79, s55, 4
    s_and_b32 s79, s79, 14
    s_lshl_b32 s79, s79, 11
    s_add_u32 s79, s79, s65
    buffer_load_dwordx4 v[132:135], v1, s[40:43], s79 offen sc1
    buffer_load_dwordx4 v[136:139], v1, s[40:43], s79 offen offset:2048 sc1
    s_lshl1_add_u32 s79, s55, 6
    s_and_b32 s79, s79, 14
    s_lshl_b32 s79, s79, 11
    s_add_u32 s79, s79, s65
    buffer_load_dwordx4 v[140:143], v1, s[40:43], s79 offen sc1
    buffer_load_dwordx4 v[144:147], v1, s[40:43], s79 offen offset:2048 sc1
    s_lshl1_add_u32 s79, s55, 8
    s_and_b32 s79, s79, 14
    s_lshl_b32 s79, s79, 11
    s_add_u32 s79, s79, s65
    buffer_load_dwordx4 v[148:151], v1, s[40:43], s79 offen sc1
    buffer_load_dwordx4 v[152:155], v1, s[40:43], s79 offen offset:2048 sc1
    s_lshl1_add_u32 s79, s55, 10
    s_and_b32 s79, s79, 14
    s_lshl_b32 s79, s79, 11
    s_add_u32 s79, s79, s65
    buffer_load_dwordx4 v[156:159], v1, s[40:43], s79 offen sc1
    buffer_load_dwordx4 v[160:163], v1, s[40:43], s79 offen offset:2048 sc1
    s_lshl1_add_u32 s79, s55, 12
    s_and_b32 s79, s79, 14
    s_lshl_b32 s79, s79, 11
    s_add_u32 s79, s79, s65
    buffer_load_dwordx4 v[164:167], v1, s[40:43], s79 offen sc1
    buffer_load_dwordx4 v[168:171], v1, s[40:43], s79 offen offset:2048 sc1
    s_lshl1_add_u32 s79, s55, 14
    s_and_b32 s79, s79, 14
    s_lshl_b32 s79, s79, 11
    s_add_u32 s79, s79, s65
    buffer_load_dwordx4 v[172:175], v1, s[40:43], s79 offen sc1
    buffer_load_dwordx4 v[176:179], v1, s[40:43], s79 offen offset:2048 sc1
    ds_write_b32 v14, v15 offset:112
    s_waitcnt vmcnt(14)
    v_lshlrev_b32 v52, 16, v116
    v_and_b32 v53, 0xffff0000, v116
    v_lshlrev_b32 v54, 16, v117
    v_and_b32 v55, 0xffff0000, v117
    v_lshlrev_b32 v56, 16, v118
    v_and_b32 v57, 0xffff0000, v118
    v_lshlrev_b32 v58, 16, v120
    v_and_b32 v59, 0xffff0000, v120
    v_lshlrev_b32 v60, 16, v121
    v_and_b32 v61, 0xffff0000, v121
    v_lshlrev_b32 v62, 16, v122
    v_and_b32 v63, 0xffff0000, v122
    v_and_b32 v9, v119, v123
    v_or_b32 v5, v119, v123
    s_waitcnt vmcnt(12)
    v_lshlrev_b32 v64, 16, v124
    v_and_b32 v65, 0xffff0000, v124
    v_lshlrev_b32 v66, 16, v125
    v_and_b32 v67, 0xffff0000, v125
    v_lshlrev_b32 v68, 16, v126
    v_and_b32 v69, 0xffff0000, v126
    v_lshlrev_b32 v70, 16, v128
    v_and_b32 v71, 0xffff0000, v128
    v_lshlrev_b32 v72, 16, v129
    v_and_b32 v73, 0xffff0000, v129
    v_lshlrev_b32 v74, 16, v130
    v_and_b32 v75, 0xffff0000, v130
    v_pk_add_f32 v[52:53], v[52:53], v[64:65]
    v_pk_add_f32 v[54:55], v[54:55], v[66:67]
    v_pk_add_f32 v[56:57], v[56:57], v[68:69]
    v_pk_add_f32 v[58:59], v[58:59], v[70:71]
    v_pk_add_f32 v[60:61], v[60:61], v[72:73]
    v_pk_add_f32 v[62:63], v[62:63], v[74:75]
    v_bfi_b32 v3, v127, v131, 0
    v_or3_b32 v5, v5, v127, v131
    v_and_b32 v9, v9, v3
    s_waitcnt vmcnt(10)
    v_lshlrev_b32 v64, 16, v132
    v_and_b32 v65, 0xffff0000, v132
    v_lshlrev_b32 v66, 16, v133
    v_and_b32 v67, 0xffff0000, v133
    v_lshlrev_b32 v68, 16, v134
    v_and_b32 v69, 0xffff0000, v134
    v_lshlrev_b32 v70, 16, v136
    v_and_b32 v71, 0xffff0000, v136
    v_lshlrev_b32 v72, 16, v137
    v_and_b32 v73, 0xffff0000, v137
    v_lshlrev_b32 v74, 16, v138
    v_and_b32 v75, 0xffff0000, v138
    v_pk_add_f32 v[52:53], v[52:53], v[64:65]
    v_pk_add_f32 v[54:55], v[54:55], v[66:67]
    v_pk_add_f32 v[56:57], v[56:57], v[68:69]
    v_pk_add_f32 v[58:59], v[58:59], v[70:71]
    v_pk_add_f32 v[60:61], v[60:61], v[72:73]
    v_pk_add_f32 v[62:63], v[62:63], v[74:75]
    v_bfi_b32 v3, v135, v139, 0
    v_or3_b32 v5, v5, v135, v139
    v_and_b32 v9, v9, v3
    s_waitcnt vmcnt(8)
    v_lshlrev_b32 v64, 16, v140
    v_and_b32 v65, 0xffff0000, v140
    v_lshlrev_b32 v66, 16, v141
    v_and_b32 v67, 0xffff0000, v141
    v_lshlrev_b32 v68, 16, v142
    v_and_b32 v69, 0xffff0000, v142
    v_lshlrev_b32 v70, 16, v144
    v_and_b32 v71, 0xffff0000, v144
    v_lshlrev_b32 v72, 16, v145
    v_and_b32 v73, 0xffff0000, v145
    v_lshlrev_b32 v74, 16, v146
    v_and_b32 v75, 0xffff0000, v146
    v_pk_add_f32 v[52:53], v[52:53], v[64:65]
    v_pk_add_f32 v[54:55], v[54:55], v[66:67]
    v_pk_add_f32 v[56:57], v[56:57], v[68:69]
    v_pk_add_f32 v[58:59], v[58:59], v[70:71]
    v_pk_add_f32 v[60:61], v[60:61], v[72:73]
    v_pk_add_f32 v[62:63], v[62:63], v[74:75]
    v_bfi_b32 v3, v143, v147, 0
    v_or3_b32 v5, v5, v143, v147
    v_and_b32 v9, v9, v3
    s_waitcnt vmcnt(6)
    v_lshlrev_b32 v64, 16, v148
    v_and_b32 v65, 0xffff0000, v148
    v_lshlrev_b32 v66, 16, v149
    v_and_b32 v67, 0xffff0000, v149
    v_lshlrev_b32 v68, 16, v150
    v_and_b32 v69, 0xffff0000, v150
    v_lshlrev_b32 v70, 16, v152
    v_and_b32 v71, 0xffff0000, v152
    v_lshlrev_b32 v72, 16, v153
    v_and_b32 v73, 0xffff0000, v153
    v_lshlrev_b32 v74, 16, v154
    v_and_b32 v75, 0xffff0000, v154
    v_pk_add_f32 v[52:53], v[52:53], v[64:65]
    v_pk_add_f32 v[54:55], v[54:55], v[66:67]
    v_pk_add_f32 v[56:57], v[56:57], v[68:69]
    v_pk_add_f32 v[58:59], v[58:59], v[70:71]
    v_pk_add_f32 v[60:61], v[60:61], v[72:73]
    v_pk_add_f32 v[62:63], v[62:63], v[74:75]
    v_bfi_b32 v3, v151, v155, 0
    v_or3_b32 v5, v5, v151, v155
    v_and_b32 v9, v9, v3
    s_waitcnt vmcnt(4)
    v_lshlrev_b32 v64, 16, v156
    v_and_b32 v65, 0xffff0000, v156
    v_lshlrev_b32 v66, 16, v157
    v_and_b32 v67, 0xffff0000, v157
    v_lshlrev_b32 v68, 16, v158
    v_and_b32 v69, 0xffff0000, v158
    v_lshlrev_b32 v70, 16, v160
    v_and_b32 v71, 0xffff0000, v160
    v_lshlrev_b32 v72, 16, v161
    v_and_b32 v73, 0xffff0000, v161
    v_lshlrev_b32 v74, 16, v162
    v_and_b32 v75, 0xffff0000, v162
    v_pk_add_f32 v[52:53], v[52:53], v[64:65]
    v_pk_add_f32 v[54:55], v[54:55], v[66:67]
    v_pk_add_f32 v[56:57], v[56:57], v[68:69]
    v_pk_add_f32 v[58:59], v[58:59], v[70:71]
    v_pk_add_f32 v[60:61], v[60:61], v[72:73]
    v_pk_add_f32 v[62:63], v[62:63], v[74:75]
    v_bfi_b32 v3, v159, v163, 0
    v_or3_b32 v5, v5, v159, v163
    v_and_b32 v9, v9, v3
    s_waitcnt vmcnt(2)
    v_lshlrev_b32 v64, 16, v164
    v_and_b32 v65, 0xffff0000, v164
    v_lshlrev_b32 v66, 16, v165
    v_and_b32 v67, 0xffff0000, v165
    v_lshlrev_b32 v68, 16, v166
    v_and_b32 v69, 0xffff0000, v166
    v_lshlrev_b32 v70, 16, v168
    v_and_b32 v71, 0xffff0000, v168
    v_lshlrev_b32 v72, 16, v169
    v_and_b32 v73, 0xffff0000, v169
    v_lshlrev_b32 v74, 16, v170
    v_and_b32 v75, 0xffff0000, v170
    v_pk_add_f32 v[52:53], v[52:53], v[64:65]
    v_pk_add_f32 v[54:55], v[54:55], v[66:67]
    v_pk_add_f32 v[56:57], v[56:57], v[68:69]
    v_pk_add_f32 v[58:59], v[58:59], v[70:71]
    v_pk_add_f32 v[60:61], v[60:61], v[72:73]
    v_pk_add_f32 v[62:63], v[62:63], v[74:75]
    v_bfi_b32 v3, v167, v171, 0
    v_or3_b32 v5, v5, v167, v171
    v_and_b32 v9, v9, v3
    s_waitcnt vmcnt(0)
    v_lshlrev_b32 v64, 16, v172
    v_and_b32 v65, 0xffff0000, v172
    v_lshlrev_b32 v66, 16, v173
    v_and_b32 v67, 0xffff0000, v173
    v_lshlrev_b32 v68, 16, v174
    v_and_b32 v69, 0xffff0000, v174
    v_lshlrev_b32 v70, 16, v176
    v_and_b32 v71, 0xffff0000, v176
    v_lshlrev_b32 v72, 16, v177
    v_and_b32 v73, 0xffff0000, v177
    v_lshlrev_b32 v74, 16, v178
    v_and_b32 v75, 0xffff0000, v178
    v_pk_add_f32 v[52:53], v[52:53], v[64:65]
    v_pk_add_f32 v[54:55], v[54:55], v[66:67]
    v_pk_add_f32 v[56:57], v[56:57], v[68:69]
    v_pk_add_f32 v[58:59], v[58:59], v[70:71]
    v_pk_add_f32 v[60:61], v[60:61], v[72:73]
    v_pk_add_f32 v[62:63], v[62:63], v[74:75]
    v_bfi_b32 v3, v175, v179, 0
    v_or3_b32 v5, v5, v175, v179
    v_and_b32 v9, v9, v3
    v_cmp_ne_u32 vcc, s61, v9
    v_cmp_ne_u32 s[68:69], s61, v5
    s_nop 1
    s_or_b64 vcc, vcc, s[68:69]
    s_cbranch_vccz L_kv_ok
    s_add_u32 s82, s82, 1
    s_cmp_gt_u32 s82, 64
    s_cbranch_scc0 L_kv_gather
L_kv_ok:
    v_pk_add_f32 v[52:53], v[52:53], v[58:59]
    v_pk_add_f32 v[54:55], v[54:55], v[60:61]
    v_pk_add_f32 v[56:57], v[56:57], v[62:63]
    v_cvt_pk_bf16_f32 v84, v52, v53
    v_cvt_pk_bf16_f32 v85, v54, v55
    v_cvt_pk_bf16_f32 v86, v56, v57
    ds_write_b128 v249, v[84:87] offset:2048
    s_mov_b32 s85, 0
L_x2:
    ds_read_b128 v[100:103], v250 offset:2048
    s_add_u32 s85, s85, 1
    s_waitcnt lgkmcnt(0)
    v_cmp_ne_u32 vcc, s61, v103
    s_cmp_gt_u32 s85, 0x40000
    s_cbranch_scc1 L_x2d
    s_cbranch_vccnz L_x2
L_x2d:
    v_cndmask_b32 v76, v84, v100, s[66:67]
    v_cndmask_b32 v79, v100, v84, s[66:67]
    v_cndmask_b32 v77, v85, v101, s[66:67]
    v_cndmask_b32 v80, v101, v85, s[66:67]
    v_cndmask_b32 v78, v86, v102, s[66:67]
    v_cndmask_b32 v81, v102, v86, s[66:67]
    s_nop 1
    v_mov_b32_dpp v82, v80 quad_perm:[1,0,3,2] row_mask:0xf bank_mask:0xf
    v_mov_b32_dpp v83, v81 quad_perm:[1,0,3,2] row_mask:0xf bank_mask:0xf
    v_cndmask_b32 v52, v82, v80, s[86:87]
    v_cndmask_b32 v54, v80, v82, s[86:87]
    v_cndmask_b32 v53, v83, v81, s[86:87]
    v_cndmask_b32 v55, v81, v83, s[86:87]
    s_nop 1
    v_mfma_f32_16x16x16_bf16 v[148:151], v[52:53], v[20:21], 0
    v_mfma_f32_16x16x16_bf16 v[152:155], v[54:55], v[22:23], 0
    v_mfma_f32_16x16x16_bf16 v[156:159], v[52:53], v[24:25], 0
    v_mfma_f32_16x16x16_bf16 v[160:163], v[54:55], v[26:27], 0
    v_mfma_f32_16x16x16_bf16 v[164:167], v[52:53], v[36:37], 0
    v_mfma_f32_16x16x16_bf16 v[168:171], v[54:55], v[38:39], 0
    v_mfma_f32_16x16x16_bf16 v[172:175], v[52:53], v[40:41], 0
    v_mfma_f32_16x16x16_bf16 v[176:179], v[54:55], v[42:43], 0
    v_mfma_f32_16x16x16_bf16 v[116:119], v[76:77], v[20:21], 0
    v_mfma_f32_16x16x16_bf16 v[120:123], v[78:79], v[22:23], 0
    v_mfma_f32_16x16x16_bf16 v[124:127], v[76:77], v[24:25], 0
    v_mfma_f32_16x16x16_bf16 v[128:131], v[78:79], v[26:27], 0
    v_mfma_f32_16x16x16_bf16 v[132:135], v[76:77], v[36:37], 0
    v_mfma_f32_16x16x16_bf16 v[136:139], v[78:79], v[38:39], 0
    v_mfma_f32_16x16x16_bf16 v[140:143], v[76:77], v[40:41], 0
    v_mfma_f32_16x16x16_bf16 v[144:147], v[78:79], v[42:43], 0
    v_add_f32 v180, v228, v148
    v_add_f32 v182, v228, v152
    v_add_f32 v184, v228, v156
    v_add_f32 v186, v228, v160
    v_add_f32 v188, v228, v164
    v_add_f32 v190, v228, v168
    v_add_f32 v192, v228, v172
    v_add_f32 v194, v228, v176
    v_rcp_f32 v180, v180
    v_rcp_f32 v182, v182
    v_rcp_f32 v184, v184
    v_rcp_f32 v186, v186
    v_rcp_f32 v188, v188
    v_rcp_f32 v190, v190
    v_rcp_f32 v192, v192
    v_rcp_f32 v194, v194
    v_mul_f32 v116, v180, v116
    v_mul_f32 v117, v180, v117
    v_mul_f32 v118, v180, v118
    v_mul_f32 v119, v180, v119
    v_mul_f32 v120, v182, v120
    v_mul_f32 v121, v182, v121
    v_mul_f32 v122, v182, v122
    v_mul_f32 v123, v182, v123
    v_cvt_pk_bf16_f32 v84, v116, v117
    v_cvt_pk_bf16_f32 v85, v118, v119
    v_cvt_pk_bf16_f32 v86, v120, v121
    v_cvt_pk_bf16_f32 v87, v122, v123
    buffer_store_dwordx4 v[84:87], v1, s[40:43], s71 offen sc1
    v_mul_f32 v124, v184, v124
    v_mul_f32 v125, v184, v125
    v_mul_f32 v126, v184, v126
    v_mul_f32 v127, v184, v127
    v_mul_f32 v128, v186, v128
    v_mul_f32 v129, v186, v129
    v_mul_f32 v130, v186, v130
    v_mul_f32 v131, v186, v131
    v_cvt_pk_bf16_f32 v88, v124, v125
    v_cvt_pk_bf16_f32 v89, v126, v127
    v_cvt_pk_bf16_f32 v90, v128, v129
    v_cvt_pk_bf16_f32 v91, v130, v131
    buffer_store_dwordx4 v[88:91], v248, s[40:43], s71 offen sc1
    v_mul_f32 v132, v188, v132
    v_mul_f32 v133, v188, v133
    v_mul_f32 v134, v188, v134
    v_mul_f32 v135, v188, v135
    v_mul_f32 v136, v190, v136
    v_mul_f32 v137, v190, v137
    v_mul_f32 v138, v190, v138
    v_mul_f32 v139, v190, v139
    v_cvt_pk_bf16_f32 v92, v132, v133
    v_cvt_pk_bf16_f32 v93, v134, v135
    v_cvt_pk_bf16_f32 v94, v136, v137
    v_cvt_pk_bf16_f32 v95, v138, v139
    buffer_store_dwordx4 v[92:95], v16, s[40:43], s71 offen sc1
    v_mul_f32 v140, v192, v140
    v_mul_f32 v141, v192, v141
    v_mul_f32 v142, v192, v142
    v_mul_f32 v143, v192, v143
    v_mul_f32 v144, v194, v144
    v_mul_f32 v145, v194, v145
    v_mul_f32 v146, v194, v146
    v_mul_f32 v147, v194, v147
    v_cvt_pk_bf16_f32 v96, v140, v141
    v_cvt_pk_bf16_f32 v97, v142, v143
    v_cvt_pk_bf16_f32 v98, v144, v145
    v_cvt_pk_bf16_f32 v99, v146, v147
    buffer_store_dwordx4 v[96:99], v255, s[40:43], s71 offen sc1
    s_waitcnt vmcnt(0)
    buffer_store_dword v241, v240, s[40:43], s64 offen sc1
    s_cmp_lg_u32 s2, 0
    s_cbranch_scc1 L_cdone
    s_cmp_lg_u32 s52, 0
    s_cbranch_scc1 L_cdone
    v_lshlrev_b32 v7, 10, v0
    s_mov_b32 s77, 65536
    s_mov_b32 s85, 0
L_spep0:
    buffer_load_dword v9, v7, s[40:43], s77 offen offset:12 sc1
    s_add_u32 s85, s85, 1
    s_waitcnt vmcnt(0)
    v_cmp_ne_u32 vcc, s61, v9
    s_cmp_gt_u32 s85, 0x8000
    s_cbranch_scc1 L_sdep0
    s_cbranch_vccz L_sdep0
    s_sleep 2
    s_branch L_spep0
L_sdep0:
    s_mov_b32 s77, 131072
    s_mov_b32 s85, 0
L_spep1:
    buffer_load_dword v9, v7, s[40:43], s77 offen offset:12 sc1
    s_add_u32 s85, s85, 1
    s_waitcnt vmcnt(0)
    v_cmp_ne_u32 vcc, s61, v9
    s_cmp_gt_u32 s85, 0x8000
    s_cbranch_scc1 L_sdep1
    s_cbranch_vccz L_sdep1
    s_sleep 2
    s_branch L_spep1
L_sdep1:
    s_mov_b32 s77, 196608
    s_mov_b32 s85, 0
L_spep2:
    buffer_load_dword v9, v7, s[40:43], s77 offen offset:12 sc1
    s_add_u32 s85, s85, 1
    s_waitcnt vmcnt(0)
    v_cmp_ne_u32 vcc, s61, v9
    s_cmp_gt_u32 s85, 0x8000
    s_cbranch_scc1 L_sdep2
    s_cbranch_vccz L_sdep2
    s_sleep 2
    s_branch L_spep2
L_sdep2:
    s_mov_b32 s77, 262144
    s_mov_b32 s85, 0
L_spep3:
    buffer_load_dword v9, v7, s[40:43], s77 offen offset:12 sc1
    s_add_u32 s85, s85, 1
    s_waitcnt vmcnt(0)
    v_cmp_ne_u32 vcc, s61, v9
    s_cmp_gt_u32 s85, 0x8000
    s_cbranch_scc1 L_sdep3
    s_cbranch_vccz L_sdep3
    s_sleep 2
    s_branch L_spep3
L_sdep3:
    s_mov_b32 s77, 0
    buffer_store_dword v241, v240, s[40:43], s77 offen sc1
L_cdone:
    v_lshrrev_b32 v11, 3, v0
    v_and_b32 v13, 7, v0
    v_lshlrev_b32 v18, 10, v11
    v_lshl_add_u32 v18, v13, 4, v18
    s_lshl3_add_u32 s77, s59, s52
    s_lshl_b32 s77, s77, 13
    s_lshl_b32 s78, s58, 7
    s_add_u32 s3, s77, s78
    buffer_load_dwordx4 v[244:247], v18, s[24:27], s3 offen
    v_lshlrev_b32 v13, 1, v13
    v_xor_b32 v13, v13, v11
    v_lshlrev_b32 v13, 4, v13
    v_lshl_add_u32 v17, v11, 8, v13
    s_lshl_b32 s77, s52, 13
    v_add_u32 v17, s77, v17
L_final:
    s_waitcnt vmcnt(0)
    v_xor_b32 v19, 16, v17
    v_mov_b32 v92, 0x3f317218
    v_lshlrev_b32 v84, 16, v244
    v_and_b32 v85, 0xffff0000, v244
    v_lshlrev_b32 v86, 16, v245
    v_and_b32 v87, 0xffff0000, v245
    v_lshlrev_b32 v88, 16, v246
    v_and_b32 v89, 0xffff0000, v246
    v_lshlrev_b32 v90, 16, v247
    v_and_b32 v91, 0xffff0000, v247
    s_waitcnt lgkmcnt(0)
    s_barrier
    ds_read_b128 v[20:23], v17 offset:0
    ds_read_b128 v[24:27], v19 offset:0
    ds_read_b128 v[28:31], v17 offset:2048
    ds_read_b128 v[32:35], v19 offset:2048
    ds_read_b128 v[36:39], v17 offset:4096
    ds_read_b128 v[40:43], v19 offset:4096
    ds_read_b128 v[44:47], v17 offset:6144
    ds_read_b128 v[48:51], v19 offset:6144
    s_waitcnt lgkmcnt(4)
    v_pk_add_f32 v[20:21], v[20:21], v[28:29]
    v_pk_add_f32 v[22:23], v[22:23], v[30:31]
    v_pk_add_f32 v[24:25], v[24:25], v[32:33]
    v_pk_add_f32 v[26:27], v[26:27], v[34:35]
    s_waitcnt lgkmcnt(2)
    v_pk_add_f32 v[20:21], v[20:21], v[36:37]
    v_pk_add_f32 v[22:23], v[22:23], v[38:39]
    v_pk_add_f32 v[24:25], v[24:25], v[40:41]
    v_pk_add_f32 v[26:27], v[26:27], v[42:43]
    s_waitcnt lgkmcnt(0)
    v_pk_add_f32 v[20:21], v[20:21], v[44:45]
    v_pk_add_f32 v[22:23], v[22:23], v[46:47]
    v_pk_add_f32 v[24:25], v[24:25], v[48:49]
    v_pk_add_f32 v[26:27], v[26:27], v[50:51]
    v_pk_fma_f32 v[84:85], v[20:21], v[92:93], v[84:85] op_sel_hi:[1,0,1]
    v_pk_fma_f32 v[86:87], v[22:23], v[92:93], v[86:87] op_sel_hi:[1,0,1]
    v_pk_fma_f32 v[88:89], v[24:25], v[92:93], v[88:89] op_sel_hi:[1,0,1]
    v_pk_fma_f32 v[90:91], v[26:27], v[92:93], v[90:91] op_sel_hi:[1,0,1]
    v_cvt_pk_bf16_f32 v20, v84, v85
    v_cvt_pk_bf16_f32 v21, v86, v87
    v_cvt_pk_bf16_f32 v22, v88, v89
    v_cvt_pk_bf16_f32 v23, v90, v91
    buffer_store_dwordx4 v[20:23], v18, s[44:47], s3 offen sc1
L_end:
    s_endpgm
L_codeend:
.section .rodata,"a"
.p2align 6
.amdhsa_kernel parallel_sum__linear_attn_block__dense_activation_mish__prompt_kernel
  .amdhsa_next_free_vgpr 256
  .amdhsa_next_free_sgpr 102
  .amdhsa_accum_offset 256
  .amdhsa_group_segment_fixed_size 0
  .amdhsa_kernarg_size 80
  .amdhsa_user_sgpr_count 2
  .amdhsa_user_sgpr_kernarg_segment_ptr 1
  .amdhsa_system_sgpr_workgroup_id_x 1
.end_amdhsa_kernel
```
